```python
import torch

def _softmax(x, axis=-1):
    return torch.softmax(x, dim=axis)
def _gelu(x):
    return torch.nn.functional.gelu(x, approximate="tanh")
def _silu(x):
    return torch.nn.functional.silu(x)
def _sigmoid(x):
    return torch.sigmoid(x)
def _layernorm(x, axis=-1, eps=1e-5):
    m = x.mean(dim=axis, keepdim=True)
    v = x.var(dim=axis, keepdim=True, unbiased=False)
    return (x - m) / torch.sqrt(v + eps)
def _scatter_add(tgt, idx, src, axis=0):
    return tgt.clone().index_add_(axis, idx, src)
def _segment_sum(src, seg, n):
    out = torch.zeros((n,) + src.shape[1:], dtype=src.dtype)
    return out.index_add_(0, seg, src)
def _pad(x, pw):
    flat = tuple(v for pair in reversed(pw) for v in pair)
    return torch.nn.functional.pad(x, flat)

kernel_name = 'parallel_sum__linear_attn_block__mixer_channel_mlp__prompt'

def setup_inputs():

    _w = (lambda a: (lambda t: t.to(torch.bfloat16) if t.is_floating_point() else t)(torch.as_tensor(a)))
    def _A_setup():
        B, S, D = 1, 2048, 576
        return {
            "x": _w((lambda *s: torch.randn(*s, dtype=torch.bfloat16) * 0.05)(B, S, D)),
            "wqkv": _w((lambda *s: torch.randn(*s, dtype=torch.bfloat16) * 0.1)(D, 3 * D)),
            "wo": _w((lambda *s: torch.randn(*s, dtype=torch.bfloat16) * 0.05)(D, D)),
        }
    _A_in = _A_setup()

    def _B_setup():
        B, S, D, F = 1, 2048, 576, 4608
        return {
            "x": _w((lambda *s: torch.randn(*s, dtype=torch.bfloat16) * 0.05)(B, S, D)),
            "w1": _w((lambda *s: torch.randn(*s, dtype=torch.bfloat16) * 1.6)(D, F) * (D ** -0.5)),
            "b1": _w((lambda *s: torch.randn(*s, dtype=torch.bfloat16) * 0.8)(F)),
            "w2": _w((lambda *s: torch.randn(*s, dtype=torch.bfloat16) * 0.05)(F, D) * (F ** -0.5)),
            "b2": _w((lambda *s: torch.randn(*s, dtype=torch.bfloat16) * 0.05)(D)),
        }
    _B_in = _B_setup()

    return {
        "A_x": _A_in["x"],
        "A_wqkv": _A_in["wqkv"],
        "A_wo": _A_in["wo"],
        "B_x": _B_in["x"],
        "B_w1": _B_in["w1"],
        "B_b1": _B_in["b1"],
        "B_w2": _B_in["w2"],
        "B_b2": _B_in["b2"],
    }

def reference(A_x, A_wqkv, A_wo, B_x, B_w1, B_b1, B_w2, B_b2):
    def _A_ref(x, wqkv, wo):
        B, S, D = x.shape
        H = 32; Dh = D // H
        qkv = (lambda x, *d: x.permute(*d))((x @ wqkv).reshape(B, S, 3, H, Dh), 2, 0, 3, 1, 4)
        q, k, v = qkv[0], qkv[1], qkv[2]
        phi = lambda t: torch.where(t > 0, t + 1, torch.exp(t)) + 1e-6
        pq, pk = phi(q), phi(k)
        kv = torch.einsum("bhsd,bhse->bhde", pk, v)
        z = torch.einsum("bhsd->bhd", pk)
        num = torch.einsum("bhqd,bhde->bhqe", pq, kv)
        den = torch.einsum("bhqd,bhd->bhq", pq, z)[..., None] + 1e-6
        o = num / den
        return (lambda x, *d: x.permute(*d))(o, 0, 2, 1, 3).reshape(B, S, D) @ wo

    def _B_ref(x, w1, b1, w2, b2):
        y = _layernorm(x, axis=-1)
        h = _gelu(torch.einsum("bsd,df->bsf", y, w1) + b1)
        return torch.einsum("bsf,fd->bsd", h, w2) + b2

    x = A_x
    xn = _layernorm(x, axis=-1)
    return x + _A_ref(xn, A_wqkv, A_wo) + _B_ref(xn, B_w1, B_b1, B_w2, B_b2)
```

```asm
; @launch grid=(256,1,1) block=(512,1,1) lds=163840
.amdgcn_target "amdgcn-amd-amdhsa--gfx950"
.text
.globl parallel_sum__linear_attn_block__mixer_channel_mlp__prompt_kernel
.p2align 8
.type parallel_sum__linear_attn_block__mixer_channel_mlp__prompt_kernel,@function
parallel_sum__linear_attn_block__mixer_channel_mlp__prompt_kernel:
  s_cmp_ge_u32 s2, 256
  s_cbranch_scc1 L_end
  s_load_dwordx16 s[64:79], s[0:1], 0
  s_load_dwordx4 s[80:83], s[0:1], 64
  s_load_dwordx2 s[84:85], s[0:1], 80
  v_lshrrev_b32 v3, 6, v0
  v_and_b32 v0, 63, v0
  v_readfirstlane_b32 s36, v3
  v_and_b32 v1, 15, v0
  v_lshrrev_b32 v2, 4, v0
  s_lshr_b32 s37, s36, 2
  s_and_b32 s38, s36, 3
  s_and_b32 s39, s2, 6
  s_lshr_b32 s40, s2, 3
  s_and_b32 s44, s40, 1
  s_or_b32 s39, s39, s44
  s_and_b32 s40, s40, 30
  s_and_b32 s44, s2, 1
  s_or_b32 s40, s40, s44
  s_lshl_b32 s88, s36, 10
  v_lshrrev_b32 v3, 3, v0
  s_lshl_b32 s44, s40, 6
  s_lshl_b32 s45, s36, 3
  s_add_u32 s44, s44, s45
  v_add_u32 v4, s44, v3
  v_mul_u32_u24 v4, 1152, v4
  v_lshrrev_b32 v5, 1, v3
  s_and_b32 s45, s36, 1
  s_lshl_b32 s45, s45, 2
  v_or_b32 v5, s45, v5
  v_and_b32 v6, 7, v0
  v_xor_b32 v6, v6, v5
  v_lshl_add_u32 v7, v6, 4, v4
  s_waitcnt lgkmcnt(0)
  s_mov_b32 s4, s64
  s_and_b32 s5, s65, 0xffff
  s_mov_b32 s6, 2359296
  s_mov_b32 s7, 0x20000
  s_mov_b32 s24, s84
  s_and_b32 s25, s85, 0xffff
  s_mov_b32 s26, 268435456
  s_mov_b32 s27, 0x20000
  s_mov_b32 s28, s82
  s_mov_b32 s29, s83
  s_add_u32 m0, s88, 90112
  s_nop 0
  buffer_load_dwordx4 v7, s[4:7], 0 offen offset:0 lds
  s_add_u32 m0, s88, 98176
  s_nop 0
  buffer_load_dwordx4 v7, s[4:7], 0 offen offset:128 lds
  s_add_u32 m0, s88, 106240
  s_nop 0
  buffer_load_dwordx4 v7, s[4:7], 0 offen offset:256 lds
  s_add_u32 m0, s88, 114304
  s_nop 0
  buffer_load_dwordx4 v7, s[4:7], 0 offen offset:384 lds
  s_add_u32 m0, s88, 122368
  s_nop 0
  buffer_load_dwordx4 v7, s[4:7], 0 offen offset:512 lds
  s_add_u32 m0, s88, 130432
  s_nop 0
  buffer_load_dwordx4 v7, s[4:7], 0 offen offset:640 lds
  s_add_u32 m0, s88, 138496
  s_nop 0
  buffer_load_dwordx4 v7, s[4:7], 0 offen offset:768 lds
  s_add_u32 m0, s88, 146560
  s_nop 0
  buffer_load_dwordx4 v7, s[4:7], 0 offen offset:896 lds
  s_add_u32 m0, s88, 154624
  s_nop 0
  buffer_load_dwordx4 v7, s[4:7], 0 offen offset:1024 lds
  s_mov_b32 s8, s66
  s_and_b32 s9, s67, 0xffff
  s_mov_b32 s10, 1990656
  s_mov_b32 s11, 0x20000
  s_mov_b32 s20, s68
  s_and_b32 s21, s69, 0xffff
  s_mov_b32 s22, 663552
  s_mov_b32 s23, 0x20000
  s_mov_b32 s12, s72
  s_and_b32 s13, s73, 0xffff
  s_mov_b32 s14, 5308416
  s_mov_b32 s15, 0x20000
  s_mov_b32 s32, s74
  s_and_b32 s33, s75, 0xffff
  s_mov_b32 s34, 9216
  s_mov_b32 s35, 0x20000
  s_mov_b32 s16, s76
  s_and_b32 s17, s77, 0xffff
  s_mov_b32 s18, 5308416
  s_mov_b32 s19, 0x20000
  s_cmp_lg_u32 s36, 0
  s_cbranch_scc1 L_nozero
  v_mov_b32 v16, 0
  v_mov_b32 v17, 0
  v_mov_b32 v18, 0
  v_mov_b32 v19, 0
  s_lshl_b32 s44, s40, 7
  s_lshl_b32 s45, s39, 2
  s_add_u32 s44, s44, s45
  s_add_u32 s44, s44, 44040192
  v_cmp_eq_u32 vcc, 0, v0
  v_mov_b32 v3, 0x7f000000
  s_nop 0
  v_cndmask_b32 v3, v3, v16, vcc
  buffer_store_dword v16, v3, s[24:27], s44 offen sc0 sc1
  s_cmp_ge_u32 s40, 16
  s_cbranch_scc1 L_nozero
  s_mul_i32 s44, s39, 17408
  s_lshl_b32 s45, s40, 10
  s_add_u32 s44, s44, s45
  s_add_u32 s44, s44, 41943040
  v_lshlrev_b32 v3, 4, v0
  buffer_store_dwordx4 v[16:19], v3, s[24:27], s44 offen sc0 sc1
L_nozero:
  s_lshl_b32 s44, s36, 6
  v_add_u32 v20, s44, v0
  s_mul_i32 s45, s39, 1152
  v_lshlrev_b32 v4, 2, v20
  buffer_load_dword v21, v4, s[32:35], s45 offen
  s_and_b32 s46, s39, 3
  s_lshl_b32 s46, s46, 4
  s_mul_i32 s47, s39, 144
  s_sub_u32 s47, s47, s46
  s_lshl_b32 s44, s36, 6
  v_add_u32 v3, s44, v0
  v_mul_u32_u24 v4, 1821, v3
  v_lshrrev_b32 v4, 16, v4
  v_mul_u32_u24 v5, 36, v4
  v_sub_u32 v5, v3, v5
  v_bfe_u32 v6, v4, 3, 1
  v_lshlrev_b32 v6, 1, v6
  v_xor_b32 v5, v5, v6
  v_mov_b32 v6, 0
  v_mov_b32 v7, 2112
  v_mov_b32 v8, 768
  v_cmp_lt_u32 vcc, 11, v5
  s_nop 1
  v_cndmask_b32 v6, v6, v7, vcc
  v_cmp_lt_u32 vcc, 23, v5
  s_nop 1
  v_cndmask_b32 v6, v6, v8, vcc
  v_lshl_add_u32 v5, v5, 4, v6
  v_mul_u32_u24 v4, 3456, v4
  v_add3_u32 v11, v4, v5, s47
  v_add_u32 v3, 512, v0
  v_mul_u32_u24 v4, 1821, v3
  v_lshrrev_b32 v4, 16, v4
  v_mul_u32_u24 v5, 36, v4
  v_sub_u32 v5, v3, v5
  v_bfe_u32 v6, v4, 3, 1
  v_lshlrev_b32 v6, 1, v6
  v_xor_b32 v5, v5, v6
  v_mov_b32 v6, 0
  v_mov_b32 v7, 2112
  v_mov_b32 v8, 768
  v_cmp_lt_u32 vcc, 11, v5
  s_nop 1
  v_cndmask_b32 v6, v6, v7, vcc
  v_cmp_lt_u32 vcc, 23, v5
  s_nop 1
  v_cndmask_b32 v6, v6, v8, vcc
  v_lshl_add_u32 v5, v5, 4, v6
  v_mul_u32_u24 v4, 3456, v4
  v_add3_u32 v104, v4, v5, s47
  s_mul_i32 s44, s36, 55296
  v_add_u32 v104, s44, v104
  s_mul_i32 s94, s36, 9216
  v_lshrrev_b32 v3, 3, v0
  v_and_b32 v4, 2, v3
  s_and_b32 s44, s36, 1
  s_lshl_b32 s44, s44, 2
  v_or_b32 v4, s44, v4
  v_and_b32 v5, 7, v0
  v_xor_b32 v4, v4, v5
  v_lshlrev_b32 v4, 4, v4
  s_lshl_b32 s44, s36, 3
  v_add_u32 v6, s44, v3
  v_mul_u32_u24 v7, 9216, v6
  s_mul_i32 s45, s39, 1152
  v_add3_u32 v12, v7, v4, s45
  v_and_b32 v4, 6, v3
  v_xor_b32 v4, v4, v5
  v_lshlrev_b32 v4, 4, v4
  s_mul_i32 s44, s39, 576
  v_add_u32 v7, s44, v6
  v_mul_u32_u24 v7, 1152, v7
  v_add_u32 v13, v7, v4
  s_mul_i32 s44, s39, 72
  v_add_u32 v7, s44, v6
  v_mul_u32_u24 v7, 1152, v7
  v_add_u32 v14, v7, v4
  v_add_u32 v13, 1024, v13
  v_add_u32 v14, 1024, v14
  s_mov_b32 s50, 0
  s_mov_b32 s51, 589824
  s_mov_b32 s52, 1179648
  s_mov_b32 s53, 1769472
  s_mov_b32 s54, 2359296
  s_mov_b32 s55, 2654208
  s_mov_b32 s56, 3244032
  s_mov_b32 s57, 3833856
  s_mov_b32 s58, 4423680
  s_mov_b32 s59, 5013504
  s_mov_b32 s60, 0
  s_mov_b32 s61, 73728
  s_mov_b32 s62, 147456
  s_mov_b32 s63, 221184
  s_mov_b32 s41, 258048
  s_mov_b32 s42, 331776
  s_mov_b32 s43, 405504
  s_mov_b32 s65, 479232
  s_mov_b32 s85, 516096
  s_mov_b32 s89, 589824
  s_add_u32 m0, s88, 16384
  s_mov_b32 s64, 0
  buffer_load_dwordx4 v11, s[8:11], s64 offen lds
  s_add_u32 m0, s88, 25600
  s_mov_b32 s64, 55296
  buffer_load_dwordx4 v11, s[8:11], s64 offen lds
  s_add_u32 m0, s88, 34816
  s_mov_b32 s64, 110592
  buffer_load_dwordx4 v11, s[8:11], s64 offen lds
  s_add_u32 m0, s88, 44032
  s_mov_b32 s64, 165888
  buffer_load_dwordx4 v11, s[8:11], s64 offen lds
  s_add_u32 m0, s94, 24576
  s_mov_b32 s64, 0
  s_cmp_eq_u32 s37, 1
  s_cselect_b64 vcc, -1, 0
  s_cbranch_vccnz L_d1
  buffer_load_dwordx4 v104, s[8:11], s64 offen lds
L_d1:
  s_add_u32 m0, s88, 53248
  s_mov_b32 s64, 221184
  buffer_load_dwordx4 v11, s[8:11], s64 offen lds
  s_add_u32 m0, s88, 62464
  s_mov_b32 s64, 276480
  buffer_load_dwordx4 v11, s[8:11], s64 offen lds
  s_add_u32 m0, s88, 71680
  s_mov_b32 s64, 331776
  buffer_load_dwordx4 v11, s[8:11], s64 offen lds
  s_add_u32 m0, s88, 80896
  s_mov_b32 s64, 387072
  buffer_load_dwordx4 v11, s[8:11], s64 offen lds
  s_add_u32 m0, s94, 61440
  s_mov_b32 s64, 221184
  s_cbranch_vccnz L_d2
  buffer_load_dwordx4 v104, s[8:11], s64 offen lds
L_d2:
  v_lshrrev_b32 v3, 1, v1
  v_xor_b32 v3, v3, v2
  v_lshlrev_b32 v3, 4, v3
  v_and_b32 v4, 7, v1
  v_lshl_add_u32 v3, v4, 7, v3
  v_lshrrev_b32 v4, 3, v1
  v_lshl_add_u32 v3, v4, 10, v3
  s_lshr_b32 s44, s36, 1
  s_lshl_b32 s44, s44, 11
  s_and_b32 s45, s36, 1
  s_lshl_b32 s46, s45, 6
  v_xor_b32 v3, s46, v3
  v_xor_b32 v4, 64, v3
  s_mul_i32 s46, s45, 32768
  s_add_u32 s46, s46, s44
  s_add_u32 s46, s46, 90112
  s_mul_i32 s47, s45, 40960
  s_add_u32 s47, s47, s44
  s_add_u32 s47, s47, 90112
  v_add_u32 v32, s46, v3
  v_add_u32 v33, s47, v4
  v_lshrrev_b32 v3, 2, v1
  v_lshl_add_u32 v3, v3, 4, v1
  v_lshlrev_b32 v24, 2, v3
  s_lshl_b32 s44, s36, 9
  v_lshl_add_u32 v25, v0, 3, s44
  v_xor_b32 v26, 512, v25
  s_lshr_b32 s44, s36, 1
  s_lshl_b32 s45, s44, 6
  v_lshl_add_u32 v27, v1, 2, s45
  s_mul_i32 s44, s44, 18432
  s_and_b32 s45, s36, 1
  s_mul_i32 s45, s45, 9216
  s_add_u32 s44, s44, s45
  s_add_u32 s44, s44, 90112
  v_lshl_add_u32 v28, v0, 4, s44
  s_mul_i32 s44, s37, 36864
  s_add_u32 s44, s44, 90112
  v_lshl_add_u32 v29, v0, 4, s44
  s_lshl_b32 s44, s37, 7
  v_lshl_add_u32 v30, v2, 4, s44
  v_mov_b32 v72, 0x3f803f80
  v_mov_b32 v73, 0x3f803f80
  v_mov_b32 v74, 0x3f803f80
  v_mov_b32 v75, 0x3f803f80
  s_mov_b32 s66, 0xaaaaaaaa
  s_mov_b32 s67, 0xaaaaaaaa
  s_mov_b32 s68, 0xcccccccc
  s_mov_b32 s69, 0xcccccccc
  s_lshr_b32 s3, s40, 1
  v_lshl_add_u32 v3, v0, 3, s36
  v_mov_b32 v10, 0x7f000000
  v_mul_u32_u24 v4, 7282, v3
  v_lshrrev_b32 v4, 16, v4
  v_mul_u32_u24 v5, 9, v4
  v_sub_u32 v5, v3, v5
  v_mul_u32_u24 v6, 21846, v5
  v_lshrrev_b32 v6, 16, v6
  v_mul_u32_u24 v7, 3, v6
  v_sub_u32 v7, v5, v7
  s_mul_i32 s45, s3, 36
  v_add_u32 v4, s45, v4
  v_mul_u32_u24 v8, 3456, v4
  v_mul_u32_u24 v6, 1152, v6
  v_lshlrev_b32 v7, 6, v7
  v_add3_u32 v8, v8, v6, v7
  s_mov_b32 s45, 324
  v_cmp_gt_u32 vcc, s45, v3
  s_nop 1
  v_cndmask_b32 v31, v10, v8, vcc
  v_mul_u32_u24 v4, 9216, v4
  v_lshl_add_u32 v4, v5, 7, v4
  v_cndmask_b32 v105, v10, v4, vcc
  v_lshlrev_b32 v4, 7, v3
  v_cndmask_b32 v108, v10, v4, vcc
  v_cmp_gt_u32 vcc, 46, v3
  s_nop 1
  v_cndmask_b32 v109, v10, v4, vcc
  v_lshrrev_b32 v3, 2, v1
  v_lshl_add_u32 v3, v2, 3, v3
  v_mul_u32_u24 v3, 576, v3
  v_and_b32 v4, 1, v0
  v_lshl_add_u32 v3, v4, 3, v3
  v_bfe_u32 v4, v0, 1, 1
  v_and_b32 v5, 1, v2
  v_lshlrev_b32 v5, 1, v5
  s_and_b32 s46, s39, 3
  s_lshl_b32 s44, s38, 3
  s_lshr_b32 s44, 100925952, s44
  s_and_b32 s44, s44, 255
  s_add_u32 s44, s44, s46
  v_add_u32 v6, s44, v4
  v_xor_b32 v6, v6, v5
  v_lshl_add_u32 v100, v6, 4, v3
  s_lshl_b32 s44, s38, 3
  s_lshr_b32 s44, 269356040, s44
  s_and_b32 s44, s44, 255
  s_add_u32 s44, s44, s46
  v_add_u32 v6, s44, v4
  v_xor_b32 v6, v6, v5
  v_lshl_add_u32 v101, v6, 4, v3
  s_lshl_b32 s44, s38, 3
  s_lshr_b32 s44, 437785618, s44
  s_and_b32 s44, s44, 255
  s_add_u32 s44, s44, s46
  v_add_u32 v6, s44, v4
  v_xor_b32 v6, v6, v5
  v_lshl_add_u32 v102, v6, 4, v3
  s_lshl_b32 s44, s38, 3
  s_lshr_b32 s44, 538975772, s44
  s_and_b32 s44, s44, 255
  s_add_u32 s44, s44, s46
  v_add_u32 v6, s44, v4
  v_xor_b32 v6, v6, v5
  v_lshl_add_u32 v103, v6, 4, v3
  s_waitcnt vmcnt(9)
  s_barrier
  ds_read_b128 v[112:115], v32 offset:0
  ds_read_b128 v[116:119], v33 offset:0
  ds_read_b128 v[120:123], v32 offset:8192
  ds_read_b128 v[124:127], v33 offset:8192
  ds_read_b128 v[128:131], v32 offset:16384
  ds_read_b128 v[132:135], v33 offset:16384
  ds_read_b128 v[136:139], v32 offset:24576
  ds_read_b128 v[140:143], v33 offset:24576
  ds_read_b128 v[144:147], v32 offset:32768
  s_mul_i32 s45, s39, 144
  buffer_load_dword v111, v31, s[8:11], s45 offen
  s_mul_i32 s45, s39, 1152
  buffer_load_dword v111, v105, s[12:15], s45 offen
  s_waitcnt lgkmcnt(8)
  v_mfma_f32_16x16x32_bf16 v[40:43], v[72:75], v[112:115], 0
  v_mfma_f32_16x16x32_bf16 v[44:47], v[112:115], v[112:115], 0
  s_waitcnt lgkmcnt(7)
  v_mfma_f32_16x16x32_bf16 v[40:43], v[72:75], v[116:119], v[40:43]
  v_mfma_f32_16x16x32_bf16 v[44:47], v[116:119], v[116:119], v[44:47]
  s_waitcnt lgkmcnt(6)
  v_mfma_f32_16x16x32_bf16 v[40:43], v[72:75], v[120:123], v[40:43]
  v_mfma_f32_16x16x32_bf16 v[44:47], v[120:123], v[120:123], v[44:47]
  s_waitcnt lgkmcnt(5)
  v_mfma_f32_16x16x32_bf16 v[40:43], v[72:75], v[124:127], v[40:43]
  v_mfma_f32_16x16x32_bf16 v[44:47], v[124:127], v[124:127], v[44:47]
  s_waitcnt lgkmcnt(4)
  v_mfma_f32_16x16x32_bf16 v[40:43], v[72:75], v[128:131], v[40:43]
  v_mfma_f32_16x16x32_bf16 v[44:47], v[128:131], v[128:131], v[44:47]
  s_waitcnt lgkmcnt(3)
  v_mfma_f32_16x16x32_bf16 v[40:43], v[72:75], v[132:135], v[40:43]
  v_mfma_f32_16x16x32_bf16 v[44:47], v[132:135], v[132:135], v[44:47]
  s_waitcnt lgkmcnt(2)
  v_mfma_f32_16x16x32_bf16 v[40:43], v[72:75], v[136:139], v[40:43]
  v_mfma_f32_16x16x32_bf16 v[44:47], v[136:139], v[136:139], v[44:47]
  s_waitcnt lgkmcnt(1)
  v_mfma_f32_16x16x32_bf16 v[40:43], v[72:75], v[140:143], v[40:43]
  v_mfma_f32_16x16x32_bf16 v[44:47], v[140:143], v[140:143], v[44:47]
  s_waitcnt lgkmcnt(0)
  v_mfma_f32_16x16x32_bf16 v[40:43], v[72:75], v[144:147], v[40:43]
  v_mfma_f32_16x16x32_bf16 v[44:47], v[144:147], v[144:147], v[44:47]
  s_nop 7
  v_cndmask_b32 v4, v44, v45, s[66:67]
  v_cndmask_b32 v5, v46, v47, s[66:67]
  v_cndmask_b32 v4, v4, v5, s[68:69]
  ds_bpermute_b32 v49, v24, v4
  v_mov_b32 v48, v40
  s_waitcnt lgkmcnt(0)
  ds_write_b64 v25, v[48:49] offset:2560
  s_waitcnt lgkmcnt(0)
  s_barrier
  ds_read_b64 v[50:51], v26 offset:2560
  s_waitcnt vmcnt(10)
  s_cmp_lg_u32 s36, 0
  s_cbranch_scc1 L_nozsig
  s_lshl_b32 s44, s39, 5
  s_add_u32 s44, s44, s40
  v_mov_b32 v9, s44
  v_mov_b32 v10, 1
  s_mov_b64 s[82:83], exec
  s_mov_b64 exec, 1
  global_store_byte v9, v10, s[28:29] sc0 sc1
  s_mov_b64 exec, s[82:83]
L_nozsig:
  s_waitcnt lgkmcnt(0)
  v_add_f32 v48, v48, v50
  v_add_f32 v49, v49, v51
  v_mul_f32 v6, 0x3ae38e39, v48
  v_mul_f32 v7, 0x3ae38e39, v49
  v_fma_f32 v7, -v6, v6, v7
  v_max_f32 v7, 0, v7
  v_add_f32 v8, 0x3727c5ac, v7
  v_rsq_f32 v8, v8
  s_nop 0
  v_mul_f32 v9, v8, v8
  v_mul_f32 v9, v9, v7
  v_add_f32 v9, 0x3727c5ac, v9
  v_rsq_f32 v10, v9
  s_nop 0
  v_mul_f32 v56, v8, v10
  v_mul_f32 v56, 0x3eeff558, v56
  v_mul_f32 v58, v6, v56
  v_sub_f32 v58, 0, v58
  v_mov_b32 v57, v56
  v_mov_b32 v59, v58
  v_mul_f32 v60, v9, v10
  v_mul_f32 v60, 0x40088e99, v60
  ds_write_b32 v27, v60 offset:2304
  v_lshlrev_b32 v4, 16, v112
  v_and_b32 v5, 0xffff0000, v112
  v_lshlrev_b32 v6, 16, v113
  v_and_b32 v7, 0xffff0000, v113
  v_lshlrev_b32 v8, 16, v114
  v_and_b32 v9, 0xffff0000, v114
  v_lshlrev_b32 v62, 16, v115
  v_and_b32 v63, 0xffff0000, v115
  v_pk_fma_f32 v[4:5], v[4:5], v[56:57], v[58:59]
  v_pk_fma_f32 v[6:7], v[6:7], v[56:57], v[58:59]
  v_pk_fma_f32 v[8:9], v[8:9], v[56:57], v[58:59]
  v_pk_fma_f32 v[62:63], v[62:63], v[56:57], v[58:59]
  v_cvt_pk_bf16_f32 v112, v4, v5
  v_cvt_pk_bf16_f32 v113, v6, v7
  v_cvt_pk_bf16_f32 v114, v8, v9
  v_cvt_pk_bf16_f32 v115, v62, v63
  ds_write_b128 v28, v[112:115] offset:0
  v_lshlrev_b32 v4, 16, v116
  v_and_b32 v5, 0xffff0000, v116
  v_lshlrev_b32 v6, 16, v117
  v_and_b32 v7, 0xffff0000, v117
  v_lshlrev_b32 v8, 16, v118
  v_and_b32 v9, 0xffff0000, v118
  v_lshlrev_b32 v62, 16, v119
  v_and_b32 v63, 0xffff0000, v119
  v_pk_fma_f32 v[4:5], v[4:5], v[56:57], v[58:59]
  v_pk_fma_f32 v[6:7], v[6:7], v[56:57], v[58:59]
  v_pk_fma_f32 v[8:9], v[8:9], v[56:57], v[58:59]
  v_pk_fma_f32 v[62:63], v[62:63], v[56:57], v[58:59]
  v_cvt_pk_bf16_f32 v116, v4, v5
  v_cvt_pk_bf16_f32 v117, v6, v7
  v_cvt_pk_bf16_f32 v118, v8, v9
  v_cvt_pk_bf16_f32 v119, v62, v63
  ds_write_b128 v28, v[116:119] offset:1024
  v_lshlrev_b32 v4, 16, v120
  v_and_b32 v5, 0xffff0000, v120
  v_lshlrev_b32 v6, 16, v121
  v_and_b32 v7, 0xffff0000, v121
  v_lshlrev_b32 v8, 16, v122
  v_and_b32 v9, 0xffff0000, v122
  v_lshlrev_b32 v62, 16, v123
  v_and_b32 v63, 0xffff0000, v123
  v_pk_fma_f32 v[4:5], v[4:5], v[56:57], v[58:59]
  v_pk_fma_f32 v[6:7], v[6:7], v[56:57], v[58:59]
  v_pk_fma_f32 v[8:9], v[8:9], v[56:57], v[58:59]
  v_pk_fma_f32 v[62:63], v[62:63], v[56:57], v[58:59]
  v_cvt_pk_bf16_f32 v120, v4, v5
  v_cvt_pk_bf16_f32 v121, v6, v7
  v_cvt_pk_bf16_f32 v122, v8, v9
  v_cvt_pk_bf16_f32 v123, v62, v63
  ds_write_b128 v28, v[120:123] offset:2048
  v_lshlrev_b32 v4, 16, v124
  v_and_b32 v5, 0xffff0000, v124
  v_lshlrev_b32 v6, 16, v125
  v_and_b32 v7, 0xffff0000, v125
  v_lshlrev_b32 v8, 16, v126
  v_and_b32 v9, 0xffff0000, v126
  v_lshlrev_b32 v62, 16, v127
  v_and_b32 v63, 0xffff0000, v127
  v_pk_fma_f32 v[4:5], v[4:5], v[56:57], v[58:59]
  v_pk_fma_f32 v[6:7], v[6:7], v[56:57], v[58:59]
  v_pk_fma_f32 v[8:9], v[8:9], v[56:57], v[58:59]
  v_pk_fma_f32 v[62:63], v[62:63], v[56:57], v[58:59]
  v_cvt_pk_bf16_f32 v124, v4, v5
  v_cvt_pk_bf16_f32 v125, v6, v7
  v_cvt_pk_bf16_f32 v126, v8, v9
  v_cvt_pk_bf16_f32 v127, v62, v63
  ds_write_b128 v28, v[124:127] offset:3072
  v_lshlrev_b32 v4, 16, v128
  v_and_b32 v5, 0xffff0000, v128
  v_lshlrev_b32 v6, 16, v129
  v_and_b32 v7, 0xffff0000, v129
  v_lshlrev_b32 v8, 16, v130
  v_and_b32 v9, 0xffff0000, v130
  v_lshlrev_b32 v62, 16, v131
  v_and_b32 v63, 0xffff0000, v131
  v_pk_fma_f32 v[4:5], v[4:5], v[56:57], v[58:59]
  v_pk_fma_f32 v[6:7], v[6:7], v[56:57], v[58:59]
  v_pk_fma_f32 v[8:9], v[8:9], v[56:57], v[58:59]
  v_pk_fma_f32 v[62:63], v[62:63], v[56:57], v[58:59]
  v_cvt_pk_bf16_f32 v128, v4, v5
  v_cvt_pk_bf16_f32 v129, v6, v7
  v_cvt_pk_bf16_f32 v130, v8, v9
  v_cvt_pk_bf16_f32 v131, v62, v63
  ds_write_b128 v28, v[128:131] offset:4096
  v_lshlrev_b32 v4, 16, v132
  v_and_b32 v5, 0xffff0000, v132
  v_lshlrev_b32 v6, 16, v133
  v_and_b32 v7, 0xffff0000, v133
  v_lshlrev_b32 v8, 16, v134
  v_and_b32 v9, 0xffff0000, v134
  v_lshlrev_b32 v62, 16, v135
  v_and_b32 v63, 0xffff0000, v135
  v_pk_fma_f32 v[4:5], v[4:5], v[56:57], v[58:59]
  v_pk_fma_f32 v[6:7], v[6:7], v[56:57], v[58:59]
  v_pk_fma_f32 v[8:9], v[8:9], v[56:57], v[58:59]
  v_pk_fma_f32 v[62:63], v[62:63], v[56:57], v[58:59]
  v_cvt_pk_bf16_f32 v132, v4, v5
  v_cvt_pk_bf16_f32 v133, v6, v7
  v_cvt_pk_bf16_f32 v134, v8, v9
  v_cvt_pk_bf16_f32 v135, v62, v63
  ds_write_b128 v28, v[132:135] offset:5120
  v_lshlrev_b32 v4, 16, v136
  v_and_b32 v5, 0xffff0000, v136
  v_lshlrev_b32 v6, 16, v137
  v_and_b32 v7, 0xffff0000, v137
  v_lshlrev_b32 v8, 16, v138
  v_and_b32 v9, 0xffff0000, v138
  v_lshlrev_b32 v62, 16, v139
  v_and_b32 v63, 0xffff0000, v139
  v_pk_fma_f32 v[4:5], v[4:5], v[56:57], v[58:59]
  v_pk_fma_f32 v[6:7], v[6:7], v[56:57], v[58:59]
  v_pk_fma_f32 v[8:9], v[8:9], v[56:57], v[58:59]
  v_pk_fma_f32 v[62:63], v[62:63], v[56:57], v[58:59]
  v_cvt_pk_bf16_f32 v136, v4, v5
  v_cvt_pk_bf16_f32 v137, v6, v7
  v_cvt_pk_bf16_f32 v138, v8, v9
  v_cvt_pk_bf16_f32 v139, v62, v63
  ds_write_b128 v28, v[136:139] offset:6144
  v_lshlrev_b32 v4, 16, v140
  v_and_b32 v5, 0xffff0000, v140
  v_lshlrev_b32 v6, 16, v141
  v_and_b32 v7, 0xffff0000, v141
  v_lshlrev_b32 v8, 16, v142
  v_and_b32 v9, 0xffff0000, v142
  v_lshlrev_b32 v62, 16, v143
  v_and_b32 v63, 0xffff0000, v143
  v_pk_fma_f32 v[4:5], v[4:5], v[56:57], v[58:59]
  v_pk_fma_f32 v[6:7], v[6:7], v[56:57], v[58:59]
  v_pk_fma_f32 v[8:9], v[8:9], v[56:57], v[58:59]
  v_pk_fma_f32 v[62:63], v[62:63], v[56:57], v[58:59]
  v_cvt_pk_bf16_f32 v140, v4, v5
  v_cvt_pk_bf16_f32 v141, v6, v7
  v_cvt_pk_bf16_f32 v142, v8, v9
  v_cvt_pk_bf16_f32 v143, v62, v63
  ds_write_b128 v28, v[140:143] offset:7168
  v_lshlrev_b32 v4, 16, v144
  v_and_b32 v5, 0xffff0000, v144
  v_lshlrev_b32 v6, 16, v145
  v_and_b32 v7, 0xffff0000, v145
  v_lshlrev_b32 v8, 16, v146
  v_and_b32 v9, 0xffff0000, v146
  v_lshlrev_b32 v62, 16, v147
  v_and_b32 v63, 0xffff0000, v147
  v_pk_fma_f32 v[4:5], v[4:5], v[56:57], v[58:59]
  v_pk_fma_f32 v[6:7], v[6:7], v[56:57], v[58:59]
  v_pk_fma_f32 v[8:9], v[8:9], v[56:57], v[58:59]
  v_pk_fma_f32 v[62:63], v[62:63], v[56:57], v[58:59]
  v_cvt_pk_bf16_f32 v144, v4, v5
  v_cvt_pk_bf16_f32 v145, v6, v7
  v_cvt_pk_bf16_f32 v146, v8, v9
  v_cvt_pk_bf16_f32 v147, v62, v63
  ds_write_b128 v28, v[144:147] offset:8192
  s_waitcnt lgkmcnt(0)
  s_barrier
  ds_read_b128 v[112:115], v29 offset:0
  ds_read_b128 v[184:187], v29 offset:18432
  ds_read_b128 v[116:119], v29 offset:1024
  ds_read_b128 v[188:191], v29 offset:19456
  ds_read_b128 v[120:123], v29 offset:2048
  ds_read_b128 v[192:195], v29 offset:20480
  ds_read_b128 v[124:127], v29 offset:3072
  ds_read_b128 v[196:199], v29 offset:21504
  ds_read_b128 v[128:131], v29 offset:4096
  ds_read_b128 v[200:203], v29 offset:22528
  ds_read_b128 v[132:135], v29 offset:5120
  ds_read_b128 v[204:207], v29 offset:23552
  ds_read_b128 v[136:139], v29 offset:6144
  ds_read_b128 v[208:211], v29 offset:24576
  ds_read_b128 v[140:143], v29 offset:7168
  ds_read_b128 v[212:215], v29 offset:25600
  ds_read_b128 v[144:147], v29 offset:8192
  ds_read_b128 v[216:219], v29 offset:26624
  ds_read_b128 v[148:151], v29 offset:9216
  ds_read_b128 v[220:223], v29 offset:27648
  ds_read_b128 v[152:155], v29 offset:10240
  ds_read_b128 v[224:227], v29 offset:28672
  ds_read_b128 v[156:159], v29 offset:11264
  ds_read_b128 v[228:231], v29 offset:29696
  ds_read_b128 v[160:163], v29 offset:12288
  ds_read_b128 v[232:235], v29 offset:30720
  ds_read_b128 v[164:167], v29 offset:13312
  ds_read_b128 v[236:239], v29 offset:31744
  ds_read_b128 v[168:171], v29 offset:14336
  ds_read_b128 v[240:243], v29 offset:32768
  ds_read_b128 v[172:175], v29 offset:15360
  ds_read_b128 v[244:247], v29 offset:33792
  ds_read_b128 v[176:179], v29 offset:16384
  ds_read_b128 v[248:251], v29 offset:34816
  ds_read_b128 v[180:183], v29 offset:17408
  ds_read_b128 v[252:255], v29 offset:35840
  s_waitcnt lgkmcnt(0)
  s_waitcnt vmcnt(6)
  v_cmp_gt_u32 vcc, 288, v20
  s_nop 1
  s_and_saveexec_b64 s[82:83], vcc
  s_cbranch_execz L_nob1
  v_lshlrev_b32 v22, 16, v21
  v_and_b32 v23, 0xffff0000, v21
  v_lshlrev_b32 v20, 3, v20
  v_mul_f32 v22, 0x3eeff558, v22
  v_mul_f32 v23, 0x3eeff558, v23
  ds_write_b64 v20, v[22:23] offset:0
L_nob1:
  s_mov_b64 exec, s[82:83]
  s_waitcnt lgkmcnt(0)
  s_barrier
  ds_read_b128 v[76:79], v30 offset:2304
  ds_read_b128 v[80:83], v30 offset:2368
  v_add_u32 v72, 16384, v100
  v_add_u32 v73, 16384, v101
  v_add_u32 v74, 16384, v102
  v_add_u32 v75, 16384, v103
  ds_read_b64_tr_b16 v[16:17], v72 offset:0
  ds_read_b64_tr_b16 v[18:19], v72 offset:2304
  ds_read_b64_tr_b16 v[20:21], v73 offset:0
  ds_read_b64_tr_b16 v[22:23], v73 offset:2304
  ds_read_b64_tr_b16 v[24:25], v74 offset:0
  ds_read_b64_tr_b16 v[26:27], v74 offset:2304
  ds_read_b64_tr_b16 v[28:29], v75 offset:0
  ds_read_b64_tr_b16 v[30:31], v75 offset:2304
  ds_read_b64_tr_b16 v[32:33], v72 offset:18432
  ds_read_b64_tr_b16 v[34:35], v72 offset:20736
  s_waitcnt lgkmcnt(6)
  v_mfma_f32_16x16x32_bf16 v[40:43], v[112:115], v[16:19], 0
  s_add_u32 m0, s88, 90112
  s_mov_b32 s64, 442368
  ds_read_b64_tr_b16 v[36:37], v73 offset:18432
  buffer_load_dwordx4 v11, s[8:11], s64 offen lds
  v_mfma_f32_16x16x32_bf16 v[44:47], v[184:187], v[16:19], 0
  s_add_u32 m0, s88, 99328
  s_mov_b32 s64, 497664
  ds_read_b64_tr_b16 v[38:39], v73 offset:20736
  buffer_load_dwordx4 v11, s[8:11], s64 offen lds
  v_mfma_f32_16x16x32_bf16 v[48:51], v[112:115], v[20:23], 0
  s_add_u32 m0, s88, 108544
  s_mov_b32 s64, 552960
  ds_read_b64_tr_b16 v[16:17], v74 offset:18432
  buffer_load_dwordx4 v11, s[8:11], s64 offen lds
  v_mfma_f32_16x16x32_bf16 v[52:55], v[184:187], v[20:23], 0
  s_add_u32 m0, s88, 117760
  s_mov_b32 s64, 608256
  ds_read_b64_tr_b16 v[18:19], v74 offset:20736
  buffer_load_dwordx4 v11, s[8:11], s64 offen lds
  s_waitcnt lgkmcnt(6)
  v_mfma_f32_16x16x32_bf16 v[56:59], v[112:115], v[24:27], 0
  s_add_u32 m0, s94, 98304
  s_mov_b32 s64, 442368
  ds_read_b64_tr_b16 v[20:21], v75 offset:18432
  s_cmp_eq_u32 s37, 1
  s_cselect_b64 vcc, -1, 0
  s_cbranch_vccnz L_d3
  buffer_load_dwordx4 v104, s[8:11], s64 offen lds
L_d3:
  v_mfma_f32_16x16x32_bf16 v[60:63], v[184:187], v[24:27], 0
  s_add_u32 m0, s88, 126976
  s_mov_b32 s64, 663552
  ds_read_b64_tr_b16 v[22:23], v75 offset:20736
  buffer_load_dwordx4 v11, s[8:11], s64 offen lds
  v_mfma_f32_16x16x32_bf16 v[64:67], v[112:115], v[28:31], 0
  s_add_u32 m0, s88, 136192
  s_mov_b32 s64, 718848
  buffer_load_dwordx4 v11, s[8:11], s64 offen lds
  v_mfma_f32_16x16x32_bf16 v[68:71], v[184:187], v[28:31], 0
  s_add_u32 m0, s88, 145408
  s_mov_b32 s64, 774144
  buffer_load_dwordx4 v11, s[8:11], s64 offen lds
  s_waitcnt lgkmcnt(4)
  v_mfma_f32_16x16x32_bf16 v[40:43], v[116:119], v[32:35], v[40:43]
  s_add_u32 m0, s88, 154624
  s_mov_b32 s64, 829440
  buffer_load_dwordx4 v11, s[8:11], s64 offen lds
  v_mfma_f32_16x16x32_bf16 v[44:47], v[188:191], v[32:35], v[44:47]
  s_add_u32 m0, s94, 135168
  s_mov_b32 s64, 663552
  s_cbranch_vccnz L_d4
  buffer_load_dwordx4 v104, s[8:11], s64 offen lds
L_d4:
  s_waitcnt lgkmcnt(0)
  s_waitcnt vmcnt(10)
  s_barrier
  v_add_u32 v72, 53248, v100
  v_add_u32 v73, 53248, v101
  v_add_u32 v74, 53248, v102
  v_add_u32 v75, 53248, v103
  v_mfma_f32_16x16x32_bf16 v[48:51], v[116:119], v[36:39], v[48:51]
  ds_read_b64_tr_b16 v[24:25], v72 offset:0
  ds_read_b64_tr_b16 v[26:27], v72 offset:2304
  v_mfma_f32_16x16x32_bf16 v[52:55], v[188:191], v[36:39], v[52:55]
  ds_read_b64_tr_b16 v[28:29], v73 offset:0
  ds_read_b64_tr_b16 v[30:31], v73 offset:2304
  v_mfma_f32_16x16x32_bf16 v[56:59], v[116:119], v[16:19], v[56:59]
  ds_read_b64_tr_b16 v[32:33], v74 offset:0
  ds_read_b64_tr_b16 v[34:35], v74 offset:2304
  v_mfma_f32_16x16x32_bf16 v[60:63], v[188:191], v[16:19], v[60:63]
  ds_read_b64_tr_b16 v[36:37], v75 offset:0
  v_mfma_f32_16x16x32_bf16 v[64:67], v[116:119], v[20:23], v[64:67]
  ds_read_b64_tr_b16 v[38:39], v75 offset:2304
  v_mfma_f32_16x16x32_bf16 v[68:71], v[188:191], v[20:23], v[68:71]
  ds_read_b64_tr_b16 v[16:17], v72 offset:18432
  s_waitcnt lgkmcnt(5)
  v_mfma_f32_16x16x32_bf16 v[40:43], v[120:123], v[24:27], v[40:43]
  s_add_u32 m0, s88, 16384
  s_mov_b32 s64, 884736
  ds_read_b64_tr_b16 v[18:19], v72 offset:20736
  buffer_load_dwordx4 v11, s[8:11], s64 offen lds
  v_mfma_f32_16x16x32_bf16 v[44:47], v[192:195], v[24:27], v[44:47]
  ds_read_b64_tr_b16 v[20:21], v73 offset:18432
  v_mfma_f32_16x16x32_bf16 v[48:51], v[120:123], v[28:31], v[48:51]
  s_add_u32 m0, s88, 25600
  s_mov_b32 s64, 940032
  ds_read_b64_tr_b16 v[22:23], v73 offset:20736
  buffer_load_dwordx4 v11, s[8:11], s64 offen lds
  v_mfma_f32_16x16x32_bf16 v[52:55], v[192:195], v[28:31], v[52:55]
  ds_read_b64_tr_b16 v[24:25], v74 offset:18432
  s_waitcnt lgkmcnt(5)
  v_mfma_f32_16x16x32_bf16 v[56:59], v[120:123], v[32:35], v[56:59]
  s_add_u32 m0, s88, 34816
  s_mov_b32 s64, 995328
  ds_read_b64_tr_b16 v[26:27], v74 offset:20736
  buffer_load_dwordx4 v11, s[8:11], s64 offen lds
  v_mfma_f32_16x16x32_bf16 v[60:63], v[192:195], v[32:35], v[60:63]
  ds_read_b64_tr_b16 v[28:29], v75 offset:18432
  v_mfma_f32_16x16x32_bf16 v[64:67], v[120:123], v[36:39], v[64:67]
  s_add_u32 m0, s88, 44032
  s_mov_b32 s64, 1050624
  ds_read_b64_tr_b16 v[30:31], v75 offset:20736
  buffer_load_dwordx4 v11, s[8:11], s64 offen lds
  v_mfma_f32_16x16x32_bf16 v[68:71], v[192:195], v[36:39], v[68:71]
  s_waitcnt lgkmcnt(4)
  v_mfma_f32_16x16x32_bf16 v[40:43], v[124:127], v[16:19], v[40:43]
  s_add_u32 m0, s94, 24576
  s_mov_b32 s64, 884736
  s_cbranch_vccnz L_d5
  buffer_load_dwordx4 v104, s[8:11], s64 offen lds
L_d5:
  v_mfma_f32_16x16x32_bf16 v[44:47], v[196:199], v[16:19], v[44:47]
  s_waitcnt lgkmcnt(0)
  s_waitcnt vmcnt(8)
  s_barrier
  v_add_u32 v72, 90112, v100
  v_add_u32 v73, 90112, v101
  v_add_u32 v74, 90112, v102
  v_add_u32 v75, 90112, v103
  v_mfma_f32_16x16x32_bf16 v[48:51], v[124:127], v[20:23], v[48:51]
  ds_read_b64_tr_b16 v[32:33], v72 offset:0
  ds_read_b64_tr_b16 v[34:35], v72 offset:2304
  v_mfma_f32_16x16x32_bf16 v[52:55], v[196:199], v[20:23], v[52:55]
  ds_read_b64_tr_b16 v[36:37], v73 offset:0
  ds_read_b64_tr_b16 v[38:39], v73 offset:2304
  v_mfma_f32_16x16x32_bf16 v[56:59], v[124:127], v[24:27], v[56:59]
  ds_read_b64_tr_b16 v[16:17], v74 offset:0
  ds_read_b64_tr_b16 v[18:19], v74 offset:2304
  v_mfma_f32_16x16x32_bf16 v[60:63], v[196:199], v[24:27], v[60:63]
  ds_read_b64_tr_b16 v[20:21], v75 offset:0
  v_mfma_f32_16x16x32_bf16 v[64:67], v[124:127], v[28:31], v[64:67]
  ds_read_b64_tr_b16 v[22:23], v75 offset:2304
  v_mfma_f32_16x16x32_bf16 v[68:71], v[196:199], v[28:31], v[68:71]
  ds_read_b64_tr_b16 v[24:25], v72 offset:18432
  s_waitcnt lgkmcnt(5)
  v_mfma_f32_16x16x32_bf16 v[40:43], v[128:131], v[32:35], v[40:43]
  s_add_u32 m0, s88, 53248
  s_mov_b32 s64, 1105920
  ds_read_b64_tr_b16 v[26:27], v72 offset:20736
  buffer_load_dwordx4 v11, s[8:11], s64 offen lds
  v_mfma_f32_16x16x32_bf16 v[44:47], v[200:203], v[32:35], v[44:47]
  ds_read_b64_tr_b16 v[28:29], v73 offset:18432
  v_mfma_f32_16x16x32_bf16 v[48:51], v[128:131], v[36:39], v[48:51]
  s_add_u32 m0, s88, 62464
  s_mov_b32 s64, 1161216
  ds_read_b64_tr_b16 v[30:31], v73 offset:20736
  buffer_load_dwordx4 v11, s[8:11], s64 offen lds
  v_mfma_f32_16x16x32_bf16 v[52:55], v[200:203], v[36:39], v[52:55]
  ds_read_b64_tr_b16 v[32:33], v74 offset:18432
  s_waitcnt lgkmcnt(5)
  v_mfma_f32_16x16x32_bf16 v[56:59], v[128:131], v[16:19], v[56:59]
  s_add_u32 m0, s88, 71680
  s_mov_b32 s64, 1216512
  ds_read_b64_tr_b16 v[34:35], v74 offset:20736
  buffer_load_dwordx4 v11, s[8:11], s64 offen lds
  v_mfma_f32_16x16x32_bf16 v[60:63], v[200:203], v[16:19], v[60:63]
  ds_read_b64_tr_b16 v[36:37], v75 offset:18432
  v_mfma_f32_16x16x32_bf16 v[64:67], v[128:131], v[20:23], v[64:67]
  s_add_u32 m0, s88, 80896
  s_mov_b32 s64, 1271808
  ds_read_b64_tr_b16 v[38:39], v75 offset:20736
  buffer_load_dwordx4 v11, s[8:11], s64 offen lds
  v_mfma_f32_16x16x32_bf16 v[68:71], v[200:203], v[20:23], v[68:71]
  s_waitcnt lgkmcnt(4)
  v_mfma_f32_16x16x32_bf16 v[40:43], v[132:135], v[24:27], v[40:43]
  s_add_u32 m0, s94, 61440
  s_mov_b32 s64, 1105920
  s_cbranch_vccnz L_d6
  buffer_load_dwordx4 v104, s[8:11], s64 offen lds
L_d6:
  v_mfma_f32_16x16x32_bf16 v[44:47], v[204:207], v[24:27], v[44:47]
  s_waitcnt lgkmcnt(0)
  s_waitcnt vmcnt(8)
  s_barrier
  v_add_u32 v72, 126976, v100
  v_add_u32 v73, 126976, v101
  v_add_u32 v74, 126976, v102
  v_add_u32 v75, 126976, v103
  v_mfma_f32_16x16x32_bf16 v[48:51], v[132:135], v[28:31], v[48:51]
  ds_read_b64_tr_b16 v[16:17], v72 offset:0
  ds_read_b64_tr_b16 v[18:19], v72 offset:2304
  v_mfma_f32_16x16x32_bf16 v[52:55], v[204:207], v[28:31], v[52:55]
  ds_read_b64_tr_b16 v[20:21], v73 offset:0
  ds_read_b64_tr_b16 v[22:23], v73 offset:2304
  v_mfma_f32_16x16x32_bf16 v[56:59], v[132:135], v[32:35], v[56:59]
  ds_read_b64_tr_b16 v[24:25], v74 offset:0
  ds_read_b64_tr_b16 v[26:27], v74 offset:2304
  v_mfma_f32_16x16x32_bf16 v[60:63], v[204:207], v[32:35], v[60:63]
  ds_read_b64_tr_b16 v[28:29], v75 offset:0
  v_mfma_f32_16x16x32_bf16 v[64:67], v[132:135], v[36:39], v[64:67]
  ds_read_b64_tr_b16 v[30:31], v75 offset:2304
  v_mfma_f32_16x16x32_bf16 v[68:71], v[204:207], v[36:39], v[68:71]
  ds_read_b64_tr_b16 v[32:33], v72 offset:18432
  s_waitcnt lgkmcnt(5)
  v_mfma_f32_16x16x32_bf16 v[40:43], v[136:139], v[16:19], v[40:43]
  s_add_u32 m0, s88, 90112
  s_mov_b32 s64, 1327104
  ds_read_b64_tr_b16 v[34:35], v72 offset:20736
  buffer_load_dwordx4 v11, s[8:11], s64 offen lds
  v_mfma_f32_16x16x32_bf16 v[44:47], v[208:211], v[16:19], v[44:47]
  ds_read_b64_tr_b16 v[36:37], v73 offset:18432
  v_mfma_f32_16x16x32_bf16 v[48:51], v[136:139], v[20:23], v[48:51]
  s_add_u32 m0, s88, 99328
  s_mov_b32 s64, 1382400
  ds_read_b64_tr_b16 v[38:39], v73 offset:20736
  buffer_load_dwordx4 v11, s[8:11], s64 offen lds
  v_mfma_f32_16x16x32_bf16 v[52:55], v[208:211], v[20:23], v[52:55]
  ds_read_b64_tr_b16 v[16:17], v74 offset:18432
  s_waitcnt lgkmcnt(5)
  v_mfma_f32_16x16x32_bf16 v[56:59], v[136:139], v[24:27], v[56:59]
  s_add_u32 m0, s88, 108544
  s_mov_b32 s64, 1437696
  ds_read_b64_tr_b16 v[18:19], v74 offset:20736
  buffer_load_dwordx4 v11, s[8:11], s64 offen lds
  v_mfma_f32_16x16x32_bf16 v[60:63], v[208:211], v[24:27], v[60:63]
  ds_read_b64_tr_b16 v[20:21], v75 offset:18432
  v_mfma_f32_16x16x32_bf16 v[64:67], v[136:139], v[28:31], v[64:67]
  s_add_u32 m0, s88, 117760
  s_mov_b32 s64, 1492992
  ds_read_b64_tr_b16 v[22:23], v75 offset:20736
  buffer_load_dwordx4 v11, s[8:11], s64 offen lds
  v_mfma_f32_16x16x32_bf16 v[68:71], v[208:211], v[28:31], v[68:71]
  s_waitcnt lgkmcnt(4)
  v_mfma_f32_16x16x32_bf16 v[40:43], v[140:143], v[32:35], v[40:43]
  s_add_u32 m0, s94, 98304
  s_mov_b32 s64, 1327104
  s_cbranch_vccnz L_d7
  buffer_load_dwordx4 v104, s[8:11], s64 offen lds
L_d7:
  v_mfma_f32_16x16x32_bf16 v[44:47], v[212:215], v[32:35], v[44:47]
  s_waitcnt lgkmcnt(0)
  s_waitcnt vmcnt(8)
  s_barrier
  v_add_u32 v72, 16384, v100
  v_add_u32 v73, 16384, v101
  v_add_u32 v74, 16384, v102
  v_add_u32 v75, 16384, v103
  v_mfma_f32_16x16x32_bf16 v[48:51], v[140:143], v[36:39], v[48:51]
  ds_read_b64_tr_b16 v[24:25], v72 offset:0
  ds_read_b64_tr_b16 v[26:27], v72 offset:2304
  v_mfma_f32_16x16x32_bf16 v[52:55], v[212:215], v[36:39], v[52:55]
  ds_read_b64_tr_b16 v[28:29], v73 offset:0
  ds_read_b64_tr_b16 v[30:31], v73 offset:2304
  v_mfma_f32_16x16x32_bf16 v[56:59], v[140:143], v[16:19], v[56:59]
  ds_read_b64_tr_b16 v[32:33], v74 offset:0
  ds_read_b64_tr_b16 v[34:35], v74 offset:2304
  v_mfma_f32_16x16x32_bf16 v[60:63], v[212:215], v[16:19], v[60:63]
  ds_read_b64_tr_b16 v[36:37], v75 offset:0
  v_mfma_f32_16x16x32_bf16 v[64:67], v[140:143], v[20:23], v[64:67]
  ds_read_b64_tr_b16 v[38:39], v75 offset:2304
  v_mfma_f32_16x16x32_bf16 v[68:71], v[212:215], v[20:23], v[68:71]
  ds_read_b64_tr_b16 v[16:17], v72 offset:18432
  s_waitcnt lgkmcnt(5)
  v_mfma_f32_16x16x32_bf16 v[40:43], v[144:147], v[24:27], v[40:43]
  s_add_u32 m0, s88, 126976
  s_mov_b32 s64, 1548288
  ds_read_b64_tr_b16 v[18:19], v72 offset:20736
  buffer_load_dwordx4 v11, s[8:11], s64 offen lds
  v_mfma_f32_16x16x32_bf16 v[44:47], v[216:219], v[24:27], v[44:47]
  ds_read_b64_tr_b16 v[20:21], v73 offset:18432
  v_mfma_f32_16x16x32_bf16 v[48:51], v[144:147], v[28:31], v[48:51]
  s_add_u32 m0, s88, 136192
  s_mov_b32 s64, 1603584
  ds_read_b64_tr_b16 v[22:23], v73 offset:20736
  buffer_load_dwordx4 v11, s[8:11], s64 offen lds
  v_mfma_f32_16x16x32_bf16 v[52:55], v[216:219], v[28:31], v[52:55]
  ds_read_b64_tr_b16 v[24:25], v74 offset:18432
  s_waitcnt lgkmcnt(5)
  v_mfma_f32_16x16x32_bf16 v[56:59], v[144:147], v[32:35], v[56:59]
  s_add_u32 m0, s88, 145408
  s_mov_b32 s64, 1658880
  ds_read_b64_tr_b16 v[26:27], v74 offset:20736
  buffer_load_dwordx4 v11, s[8:11], s64 offen lds
  v_mfma_f32_16x16x32_bf16 v[60:63], v[216:219], v[32:35], v[60:63]
  ds_read_b64_tr_b16 v[28:29], v75 offset:18432
  v_mfma_f32_16x16x32_bf16 v[64:67], v[144:147], v[36:39], v[64:67]
  s_add_u32 m0, s88, 154624
  s_mov_b32 s64, 1714176
  ds_read_b64_tr_b16 v[30:31], v75 offset:20736
  buffer_load_dwordx4 v11, s[8:11], s64 offen lds
  v_mfma_f32_16x16x32_bf16 v[68:71], v[216:219], v[36:39], v[68:71]
  s_waitcnt lgkmcnt(4)
  v_mfma_f32_16x16x32_bf16 v[40:43], v[148:151], v[16:19], v[40:43]
  s_add_u32 m0, s94, 135168
  s_mov_b32 s64, 1548288
  s_cbranch_vccnz L_d8
  buffer_load_dwordx4 v104, s[8:11], s64 offen lds
L_d8:
  v_mfma_f32_16x16x32_bf16 v[44:47], v[220:223], v[16:19], v[44:47]
  s_waitcnt lgkmcnt(0)
  s_waitcnt vmcnt(8)
  s_barrier
  v_add_u32 v72, 53248, v100
  v_add_u32 v73, 53248, v101
  v_add_u32 v74, 53248, v102
  v_add_u32 v75, 53248, v103
  v_mfma_f32_16x16x32_bf16 v[48:51], v[148:151], v[20:23], v[48:51]
  ds_read_b64_tr_b16 v[32:33], v72 offset:0
  ds_read_b64_tr_b16 v[34:35], v72 offset:2304
  v_mfma_f32_16x16x32_bf16 v[52:55], v[220:223], v[20:23], v[52:55]
  ds_read_b64_tr_b16 v[36:37], v73 offset:0
  ds_read_b64_tr_b16 v[38:39], v73 offset:2304
  v_mfma_f32_16x16x32_bf16 v[56:59], v[148:151], v[24:27], v[56:59]
  ds_read_b64_tr_b16 v[16:17], v74 offset:0
  ds_read_b64_tr_b16 v[18:19], v74 offset:2304
  v_mfma_f32_16x16x32_bf16 v[60:63], v[220:223], v[24:27], v[60:63]
  ds_read_b64_tr_b16 v[20:21], v75 offset:0
  v_mfma_f32_16x16x32_bf16 v[64:67], v[148:151], v[28:31], v[64:67]
  ds_read_b64_tr_b16 v[22:23], v75 offset:2304
  v_mfma_f32_16x16x32_bf16 v[68:71], v[220:223], v[28:31], v[68:71]
  ds_read_b64_tr_b16 v[24:25], v72 offset:18432
  s_waitcnt lgkmcnt(5)
  v_mfma_f32_16x16x32_bf16 v[40:43], v[152:155], v[32:35], v[40:43]
  s_add_u32 m0, s88, 16384
  s_mov_b32 s64, 1769472
  v_mul_f32 v84, 0x3fb8aa3b, v76
  v_mul_f32 v85, 0x3fb8aa3b, v77
  ds_read_b64_tr_b16 v[26:27], v72 offset:20736
  buffer_load_dwordx4 v11, s[8:11], s64 offen lds
  v_mfma_f32_16x16x32_bf16 v[44:47], v[224:227], v[32:35], v[44:47]
  v_mul_f32 v86, 0x3fb8aa3b, v78
  v_mul_f32 v87, 0x3fb8aa3b, v79
  ds_read_b64_tr_b16 v[28:29], v73 offset:18432
  v_mfma_f32_16x16x32_bf16 v[48:51], v[152:155], v[36:39], v[48:51]
  s_add_u32 m0, s88, 25600
  s_mov_b32 s64, 1824768
  v_mul_f32 v88, 0x3fb8aa3b, v80
  v_mul_f32 v89, 0x3fb8aa3b, v81
  ds_read_b64_tr_b16 v[30:31], v73 offset:20736
  buffer_load_dwordx4 v11, s[8:11], s64 offen lds
  v_mfma_f32_16x16x32_bf16 v[52:55], v[224:227], v[36:39], v[52:55]
  v_mul_f32 v90, 0x3fb8aa3b, v82
  v_mul_f32 v91, 0x3fb8aa3b, v83
  ds_read_b64_tr_b16 v[32:33], v74 offset:18432
  s_waitcnt lgkmcnt(5)
  v_mfma_f32_16x16x32_bf16 v[56:59], v[152:155], v[16:19], v[56:59]
  s_add_u32 m0, s88, 34816
  s_mov_b32 s64, 1880064
  v_mov_b32 v92, 0x358637bd
  v_lshlrev_b32 v3, 4, v0
  ds_read_b64_tr_b16 v[34:35], v74 offset:20736
  buffer_load_dwordx4 v11, s[8:11], s64 offen lds
  v_mfma_f32_16x16x32_bf16 v[60:63], v[224:227], v[16:19], v[60:63]
  v_lshrrev_b32 v5, 1, v2
  v_lshlrev_b32 v5, 3, v5
  ds_read_b64_tr_b16 v[36:37], v75 offset:18432
  v_mfma_f32_16x16x32_bf16 v[64:67], v[152:155], v[20:23], v[64:67]
  s_add_u32 m0, s88, 44032
  s_mov_b32 s64, 1935360
  v_xor_b32 v5, v5, v1
  v_lshlrev_b32 v5, 3, v5
  ds_read_b64_tr_b16 v[38:39], v75 offset:20736
  buffer_load_dwordx4 v11, s[8:11], s64 offen lds
  v_mfma_f32_16x16x32_bf16 v[68:71], v[224:227], v[20:23], v[68:71]
  v_lshl_add_u32 v5, v2, 7, v5
  s_waitcnt lgkmcnt(4)
  v_mfma_f32_16x16x32_bf16 v[40:43], v[156:159], v[24:27], v[40:43]
  s_add_u32 m0, s94, 24576
  s_mov_b32 s64, 1769472
  s_lshl_b32 s48, s38, 3
  s_lshr_b32 s48, 50462976, s48
  s_and_b32 s48, s48, 255
  s_lshl_b32 s48, s48, 10
  s_mul_i32 s49, s37, 5120
  s_add_u32 s48, s48, s49
  s_add_u32 s48, s48, 2560
  v_add_u32 v93, s48, v5
  s_cbranch_vccnz L_d9
  buffer_load_dwordx4 v104, s[8:11], s64 offen lds
L_d9:
  v_mfma_f32_16x16x32_bf16 v[44:47], v[228:231], v[24:27], v[44:47]
  s_lshl_b32 s48, s38, 3
  s_lshr_b32 s48, 33619972, s48
  s_and_b32 s48, s48, 255
  s_lshl_b32 s48, s48, 10
  s_mul_i32 s49, s37, 5120
  s_add_u32 s49, s49, s48
  s_add_u32 s49, s49, 2560
  v_add_u32 v6, s49, v5
  s_mul_i32 s49, s37, 10240
  s_add_u32 s49, s49, s48
  s_add_u32 s49, s49, 16384
  v_add_u32 v94, s49, v3
  s_cmp_eq_u32 s38, 0
  s_cselect_b64 s[78:79], -1, 0
  v_cndmask_b32 v94, v94, v6, s[78:79]
  s_waitcnt lgkmcnt(0)
  s_waitcnt vmcnt(8)
  s_barrier
  v_add_u32 v72, 90112, v100
  v_add_u32 v73, 90112, v101
  v_add_u32 v74, 90112, v102
  v_add_u32 v75, 90112, v103
  v_mfma_f32_16x16x32_bf16 v[48:51], v[156:159], v[28:31], v[48:51]
  s_lshl_b32 s48, s38, 3
  s_lshr_b32 s48, 100992003, s48
  s_and_b32 s48, s48, 255
  s_lshl_b32 s48, s48, 10
  s_mul_i32 s49, s37, 10240
  s_add_u32 s48, s48, s49
  s_add_u32 s48, s48, 16384
  v_add_u32 v95, s48, v3
  ds_read_b64_tr_b16 v[16:17], v72 offset:0
  ds_read_b64_tr_b16 v[18:19], v72 offset:2304
  v_mfma_f32_16x16x32_bf16 v[52:55], v[228:231], v[28:31], v[52:55]
  s_lshl_b32 s48, s38, 3
  s_lshr_b32 s48, 403245063, s48
  s_and_b32 s48, s48, 255
  s_lshl_b32 s48, s48, 10
  s_mul_i32 s49, s37, 10240
  s_add_u32 s48, s48, s49
  s_add_u32 s48, s48, 16384
  v_add_u32 v96, s48, v3
  ds_read_b64_tr_b16 v[20:21], v73 offset:0
  ds_read_b64_tr_b16 v[22:23], v73 offset:2304
  v_mfma_f32_16x16x32_bf16 v[56:59], v[156:159], v[32:35], v[56:59]
  s_lshl_b32 s49, s36, 2
  s_lshr_b32 s48, 572592384, s49
  s_and_b32 s48, s48, 15
  s_add_u32 s49, s48, 5
  s_lshl_b32 s49, s49, 10
  v_add_u32 v97, s49, v3
  s_lshl_b32 s49, s48, 4
  v_lshl_add_u32 v9, v2, 2, s49
  ds_read_b64_tr_b16 v[24:25], v74 offset:0
  ds_read_b64_tr_b16 v[26:27], v74 offset:2304
  v_mfma_f32_16x16x32_bf16 v[60:63], v[228:231], v[32:35], v[60:63]
  s_lshl_b32 s49, s36, 2
  s_lshr_b32 s48, 840044560, s49
  s_and_b32 s48, s48, 15
  s_lshl_b32 s49, s48, 10
  v_add_u32 v99, s49, v3
  s_lshl_b32 s49, s48, 4
  v_add_u32 v7, s49, v1
  ds_read_b64_tr_b16 v[28:29], v75 offset:0
  v_mfma_f32_16x16x32_bf16 v[64:67], v[156:159], v[36:39], v[64:67]
  v_mul_u32_u24 v8, 57, v7
  v_lshrrev_b32 v8, 10, v8
  ds_read_b64_tr_b16 v[30:31], v75 offset:2304
  v_mfma_f32_16x16x32_bf16 v[68:71], v[228:231], v[36:39], v[68:71]
  v_mul_u32_u24 v8, 18, v8
  v_sub_u32 v107, v9, v8
  ds_read_b64_tr_b16 v[32:33], v72 offset:18432
  s_waitcnt lgkmcnt(5)
  v_mfma_f32_16x16x32_bf16 v[40:43], v[160:163], v[16:19], v[40:43]
  s_add_u32 m0, s88, 53248
  s_mov_b32 s48, 72
  v_cmp_gt_u32 s[78:79], s48, v7
  v_mov_b32 v8, 0x10000
  ds_read_b64_tr_b16 v[34:35], v72 offset:20736
  buffer_load_dwordx4 v12, s[12:15], s50 offen offset:0 lds
  v_mfma_f32_16x16x32_bf16 v[44:47], v[232:235], v[16:19], v[44:47]
  v_cndmask_b32 v107, v8, v107, s[78:79]
  ds_read_b64_tr_b16 v[36:37], v73 offset:18432
  v_mfma_f32_16x16x32_bf16 v[48:51], v[160:163], v[20:23], v[48:51]
  s_add_u32 m0, s88, 61440
  s_lshl_b32 s49, s36, 2
  s_lshr_b32 s48, 279347, s49
  s_and_b32 s48, s48, 15
  s_add_u32 s49, s48, 5
  s_lshl_b32 s49, s49, 10
  v_add_u32 v98, s49, v3
  s_lshl_b32 s49, s48, 4
  v_lshl_add_u32 v9, v2, 2, s49
  ds_read_b64_tr_b16 v[38:39], v73 offset:20736
  buffer_load_dwordx4 v12, s[12:15], s51 offen offset:0 lds
  v_mfma_f32_16x16x32_bf16 v[52:55], v[232:235], v[20:23], v[52:55]
  s_lshl_b32 s49, s36, 2
  s_lshr_b32 s48, 275506, s49
  s_and_b32 s48, s48, 15
  s_lshl_b32 s49, s48, 10
  v_add_u32 v106, s49, v3
  s_lshl_b32 s49, s48, 4
  v_add_u32 v7, s49, v1
  ds_read_b64_tr_b16 v[16:17], v74 offset:18432
  s_waitcnt lgkmcnt(5)
  v_mfma_f32_16x16x32_bf16 v[56:59], v[160:163], v[24:27], v[56:59]
  s_add_u32 m0, s88, 69632
  v_mul_u32_u24 v8, 57, v7
  v_lshrrev_b32 v8, 10, v8
  ds_read_b64_tr_b16 v[18:19], v74 offset:20736
  buffer_load_dwordx4 v12, s[12:15], s52 offen offset:0 lds
  v_mfma_f32_16x16x32_bf16 v[60:63], v[232:235], v[24:27], v[60:63]
  v_mul_u32_u24 v8, 18, v8
  v_sub_u32 v104, v9, v8
  ds_read_b64_tr_b16 v[20:21], v75 offset:18432
  v_mfma_f32_16x16x32_bf16 v[64:67], v[160:163], v[28:31], v[64:67]
  s_add_u32 m0, s88, 77824
  s_cmp_lt_u32 s36, 5
  s_cselect_b32 s48, 72, 0
  v_cmp_gt_u32 s[78:79], s48, v7
  v_mov_b32 v8, 0x10000
  ds_read_b64_tr_b16 v[22:23], v75 offset:20736
  buffer_load_dwordx4 v12, s[12:15], s53 offen offset:0 lds
  v_mfma_f32_16x16x32_bf16 v[68:71], v[232:235], v[28:31], v[68:71]
  v_cndmask_b32 v104, v8, v104, s[78:79]
  s_waitcnt lgkmcnt(4)
  v_mfma_f32_16x16x32_bf16 v[40:43], v[164:167], v[32:35], v[40:43]
  s_add_u32 m0, s88, 86016
  s_lshl_b32 s48, s36, 4
  v_add_u32 v7, s48, v0
  v_mul_u32_u24 v8, 57, v7
  s_cbranch_vccnz L_d10
  buffer_load_dwordx4 v12, s[12:15], s54 offen offset:0 lds
L_d10:
  v_mfma_f32_16x16x32_bf16 v[44:47], v[236:239], v[32:35], v[44:47]
  v_lshrrev_b32 v8, 10, v8
  v_mul_u32_u24 v8, 320, v8
  s_waitcnt lgkmcnt(0)
  s_waitcnt vmcnt(8)
  s_barrier
  v_add_u32 v72, 126976, v100
  v_add_u32 v73, 126976, v101
  v_add_u32 v74, 126976, v102
  v_add_u32 v75, 126976, v103
  v_and_b32 v110, 7, v0
  v_lshlrev_b32 v110, 2, v110
  s_lshl_b32 s44, s39, 5
  v_add_u32 v110, s44, v110
  global_load_dword v110, v110, s[28:29] sc0 sc1
  v_mfma_f32_16x16x32_bf16 v[48:51], v[164:167], v[36:39], v[48:51]
  v_lshl_add_u32 v8, v7, 2, v8
  v_mov_b32 v9, 0x7f000000
  ds_read_b64_tr_b16 v[24:25], v72 offset:0
  ds_read_b64_tr_b16 v[26:27], v72 offset:2304
  v_mfma_f32_16x16x32_bf16 v[52:55], v[236:239], v[36:39], v[52:55]
  v_cmp_gt_u32 s[78:79], 16, v0
  v_mov_b32 v10, 72
  ds_read_b64_tr_b16 v[28:29], v73 offset:0
  ds_read_b64_tr_b16 v[30:31], v73 offset:2304
  v_mfma_f32_16x16x32_bf16 v[56:59], v[164:167], v[16:19], v[56:59]
  v_cndmask_b32 v8, v9, v8, s[78:79]
  v_cmp_lt_u32 s[78:79], v7, v10
  ds_read_b64_tr_b16 v[32:33], v74 offset:0
  ds_read_b64_tr_b16 v[34:35], v74 offset:2304
  v_mfma_f32_16x16x32_bf16 v[60:63], v[236:239], v[16:19], v[60:63]
  v_cndmask_b32 v105, v9, v8, s[78:79]
  ds_read_b64_tr_b16 v[36:37], v75 offset:0
  v_mfma_f32_16x16x32_bf16 v[64:67], v[164:167], v[20:23], v[64:67]
  ds_read_b64_tr_b16 v[38:39], v75 offset:2304
  v_mfma_f32_16x16x32_bf16 v[68:71], v[236:239], v[20:23], v[68:71]
  ds_read_b64_tr_b16 v[16:17], v72 offset:18432
  s_waitcnt lgkmcnt(5)
  v_mfma_f32_16x16x32_bf16 v[40:43], v[168:171], v[24:27], v[40:43]
  s_add_u32 m0, s88, 90112
  ds_read_b64_tr_b16 v[18:19], v72 offset:20736
  buffer_load_dwordx4 v12, s[12:15], s55 offen offset:0 lds
  v_mfma_f32_16x16x32_bf16 v[44:47], v[240:243], v[24:27], v[44:47]
  ds_read_b64_tr_b16 v[20:21], v73 offset:18432
  v_mfma_f32_16x16x32_bf16 v[48:51], v[168:171], v[28:31], v[48:51]
  s_add_u32 m0, s88, 98304
  ds_read_b64_tr_b16 v[22:23], v73 offset:20736
  buffer_load_dwordx4 v12, s[12:15], s56 offen offset:0 lds
  v_mfma_f32_16x16x32_bf16 v[52:55], v[240:243], v[28:31], v[52:55]
  ds_read_b64_tr_b16 v[24:25], v74 offset:18432
  s_waitcnt lgkmcnt(5)
  v_mfma_f32_16x16x32_bf16 v[56:59], v[168:171], v[32:35], v[56:59]
  s_add_u32 m0, s88, 106496
  ds_read_b64_tr_b16 v[26:27], v74 offset:20736
  buffer_load_dwordx4 v12, s[12:15], s57 offen offset:0 lds
  v_mfma_f32_16x16x32_bf16 v[60:63], v[240:243], v[32:35], v[60:63]
  ds_read_b64_tr_b16 v[28:29], v75 offset:18432
  v_mfma_f32_16x16x32_bf16 v[64:67], v[168:171], v[36:39], v[64:67]
  s_add_u32 m0, s88, 114688
  ds_read_b64_tr_b16 v[30:31], v75 offset:20736
  buffer_load_dwordx4 v12, s[12:15], s58 offen offset:0 lds
  v_mfma_f32_16x16x32_bf16 v[68:71], v[240:243], v[36:39], v[68:71]
  s_waitcnt lgkmcnt(4)
  v_mfma_f32_16x16x32_bf16 v[40:43], v[172:175], v[16:19], v[40:43]
  s_add_u32 m0, s88, 122880
  s_cbranch_vccnz L_d11
  buffer_load_dwordx4 v12, s[12:15], s59 offen offset:0 lds
L_d11:
  v_mfma_f32_16x16x32_bf16 v[44:47], v[244:247], v[16:19], v[44:47]
  s_waitcnt lgkmcnt(0)
  s_waitcnt vmcnt(9)
  s_barrier
  v_add_u32 v72, 16384, v100
  v_add_u32 v73, 16384, v101
  v_add_u32 v74, 16384, v102
  v_add_u32 v75, 16384, v103
  v_mfma_f32_16x16x32_bf16 v[48:51], v[172:175], v[20:23], v[48:51]
  ds_read_b64_tr_b16 v[32:33], v72 offset:0
  ds_read_b64_tr_b16 v[34:35], v72 offset:2304
  v_mfma_f32_16x16x32_bf16 v[52:55], v[244:247], v[20:23], v[52:55]
  ds_read_b64_tr_b16 v[36:37], v73 offset:0
  ds_read_b64_tr_b16 v[38:39], v73 offset:2304
  v_mfma_f32_16x16x32_bf16 v[56:59], v[172:175], v[24:27], v[56:59]
  ds_read_b64_tr_b16 v[16:17], v74 offset:0
  ds_read_b64_tr_b16 v[18:19], v74 offset:2304
  v_mfma_f32_16x16x32_bf16 v[60:63], v[244:247], v[24:27], v[60:63]
  ds_read_b64_tr_b16 v[20:21], v75 offset:0
  v_mfma_f32_16x16x32_bf16 v[64:67], v[172:175], v[28:31], v[64:67]
  ds_read_b64_tr_b16 v[22:23], v75 offset:2304
  v_mfma_f32_16x16x32_bf16 v[68:71], v[244:247], v[28:31], v[68:71]
  ds_read_b64_tr_b16 v[24:25], v72 offset:18432
  s_waitcnt lgkmcnt(5)
  v_mfma_f32_16x16x32_bf16 v[40:43], v[176:179], v[32:35], v[40:43]
  s_add_u32 m0, s88, 126848
  ds_read_b64_tr_b16 v[26:27], v72 offset:20736
  buffer_load_dwordx4 v12, s[12:15], s50 offen offset:128 lds
  v_mfma_f32_16x16x32_bf16 v[44:47], v[248:251], v[32:35], v[44:47]
  ds_read_b64_tr_b16 v[28:29], v73 offset:18432
  v_mfma_f32_16x16x32_bf16 v[48:51], v[176:179], v[36:39], v[48:51]
  s_add_u32 m0, s88, 135040
  ds_read_b64_tr_b16 v[30:31], v73 offset:20736
  buffer_load_dwordx4 v12, s[12:15], s51 offen offset:128 lds
  v_mfma_f32_16x16x32_bf16 v[52:55], v[248:251], v[36:39], v[52:55]
  ds_read_b64_tr_b16 v[32:33], v74 offset:18432
  s_waitcnt lgkmcnt(5)
  v_mfma_f32_16x16x32_bf16 v[56:59], v[176:179], v[16:19], v[56:59]
  s_add_u32 m0, s88, 143232
  ds_read_b64_tr_b16 v[34:35], v74 offset:20736
  buffer_load_dwordx4 v12, s[12:15], s52 offen offset:128 lds
  v_mfma_f32_16x16x32_bf16 v[60:63], v[248:251], v[16:19], v[60:63]
  ds_read_b64_tr_b16 v[36:37], v75 offset:18432
  v_mfma_f32_16x16x32_bf16 v[64:67], v[176:179], v[20:23], v[64:67]
  s_add_u32 m0, s88, 151424
  ds_read_b64_tr_b16 v[38:39], v75 offset:20736
  buffer_load_dwordx4 v12, s[12:15], s53 offen offset:128 lds
  v_mfma_f32_16x16x32_bf16 v[68:71], v[248:251], v[20:23], v[68:71]
  s_waitcnt lgkmcnt(4)
  v_mfma_f32_16x16x32_bf16 v[40:43], v[180:183], v[24:27], v[40:43]
  s_add_u32 m0, s88, 159616
  s_cbranch_vccnz L_d12
  buffer_load_dwordx4 v12, s[12:15], s54 offen offset:128 lds
L_d12:
  v_mfma_f32_16x16x32_bf16 v[44:47], v[252:255], v[24:27], v[44:47]
  v_mfma_f32_16x16x32_bf16 v[48:51], v[180:183], v[28:31], v[48:51]
  v_mfma_f32_16x16x32_bf16 v[52:55], v[252:255], v[28:31], v[52:55]
  s_waitcnt lgkmcnt(2)
  v_mfma_f32_16x16x32_bf16 v[56:59], v[180:183], v[32:35], v[56:59]
  v_mfma_f32_16x16x32_bf16 v[60:63], v[252:255], v[32:35], v[60:63]
  s_waitcnt lgkmcnt(0)
  v_mfma_f32_16x16x32_bf16 v[64:67], v[180:183], v[36:39], v[64:67]
  v_mfma_f32_16x16x32_bf16 v[68:71], v[252:255], v[36:39], v[68:71]
  s_waitcnt vmcnt(9)
  s_barrier
  s_mul_i32 s45, s39, 663552
  s_mul_i32 s47, s3, 41472
  s_add_u32 s45, s45, s47
  buffer_load_dword v111, v108, s[16:19], s45 offen
  s_mul_i32 s45, s39, 82944
  s_mul_i32 s47, s3, 5760
  s_add_u32 s45, s45, s47
  buffer_load_dword v111, v109, s[20:23], s45 offen
  v_mul_f32 v3, v64, v84
  v_mul_f32 v5, v65, v85
  v_exp_f32_e64 v3, v3 clamp
  v_exp_f32_e64 v5, v5 clamp
  v_fma_f32 v4, v64, v76, v92
  v_fma_f32 v6, v65, v77, v92
  v_max_f32 v4, v4, v92
  v_max_f32 v6, v6, v92
  v_add_f32 v64, v3, v4
  v_add_f32 v65, v5, v6
  v_mul_f32 v3, v66, v86
  v_mul_f32 v5, v67, v87
  v_exp_f32_e64 v3, v3 clamp
  v_exp_f32_e64 v5, v5 clamp
  v_fma_f32 v4, v66, v78, v92
  v_fma_f32 v6, v67, v79, v92
  v_max_f32 v4, v4, v92
  v_max_f32 v6, v6, v92
  v_add_f32 v66, v3, v4
  v_add_f32 v67, v5, v6
  v_mul_f32 v3, v68, v88
  v_mul_f32 v5, v69, v89
  v_exp_f32_e64 v3, v3 clamp
  v_exp_f32_e64 v5, v5 clamp
  v_fma_f32 v4, v68, v80, v92
  v_fma_f32 v6, v69, v81, v92
  v_max_f32 v4, v4, v92
  v_max_f32 v6, v6, v92
  v_add_f32 v68, v3, v4
  v_add_f32 v69, v5, v6
  v_mul_f32 v3, v70, v90
  v_mul_f32 v5, v71, v91
  v_exp_f32_e64 v3, v3 clamp
  v_exp_f32_e64 v5, v5 clamp
  v_fma_f32 v4, v70, v82, v92
  v_fma_f32 v6, v71, v83, v92
  v_max_f32 v4, v4, v92
  v_max_f32 v6, v6, v92
  v_add_f32 v70, v3, v4
  v_add_f32 v71, v5, v6
  v_cvt_pk_bf16_f32 v64, v64, v65
  v_cvt_pk_bf16_f32 v65, v66, v67
  v_cvt_pk_bf16_f32 v66, v68, v69
  v_cvt_pk_bf16_f32 v67, v70, v71
  ds_write_b128 v96, v[64:67]
  s_cmp_ge_u32 s38, 2
  s_cbranch_scc1 L_e2k
  v_mul_f32 v56, v56, v76
  v_mul_f32 v57, v57, v77
  v_mul_f32 v58, v58, v78
  v_mul_f32 v59, v59, v79
  v_mul_f32 v60, v60, v80
  v_mul_f32 v61, v61, v81
  v_mul_f32 v62, v62, v82
  v_mul_f32 v63, v63, v83
  s_branch L_e2d
L_e2k:
  v_mul_f32 v3, v56, v84
  v_mul_f32 v5, v57, v85
  v_exp_f32_e64 v3, v3 clamp
  v_exp_f32_e64 v5, v5 clamp
  v_fma_f32 v4, v56, v76, v92
  v_fma_f32 v6, v57, v77, v92
  v_max_f32 v4, v4, v92
  v_max_f32 v6, v6, v92
  v_add_f32 v56, v3, v4
  v_add_f32 v57, v5, v6
  v_mul_f32 v3, v58, v86
  v_mul_f32 v5, v59, v87
  v_exp_f32_e64 v3, v3 clamp
  v_exp_f32_e64 v5, v5 clamp
  v_fma_f32 v4, v58, v78, v92
  v_fma_f32 v6, v59, v79, v92
  v_max_f32 v4, v4, v92
  v_max_f32 v6, v6, v92
  v_add_f32 v58, v3, v4
  v_add_f32 v59, v5, v6
  v_mul_f32 v3, v60, v88
  v_mul_f32 v5, v61, v89
  v_exp_f32_e64 v3, v3 clamp
  v_exp_f32_e64 v5, v5 clamp
  v_fma_f32 v4, v60, v80, v92
  v_fma_f32 v6, v61, v81, v92
  v_max_f32 v4, v4, v92
  v_max_f32 v6, v6, v92
  v_add_f32 v60, v3, v4
  v_add_f32 v61, v5, v6
  v_mul_f32 v3, v62, v90
  v_mul_f32 v5, v63, v91
  v_exp_f32_e64 v3, v3 clamp
  v_exp_f32_e64 v5, v5 clamp
  v_fma_f32 v4, v62, v82, v92
  v_fma_f32 v6, v63, v83, v92
  v_max_f32 v4, v4, v92
  v_max_f32 v6, v6, v92
  v_add_f32 v62, v3, v4
  v_add_f32 v63, v5, v6
L_e2d:
  s_nop 1
  v_cvt_pk_bf16_f32 v56, v56, v57
  v_cvt_pk_bf16_f32 v57, v58, v59
  v_cvt_pk_bf16_f32 v58, v60, v61
  v_cvt_pk_bf16_f32 v59, v62, v63
  ds_write_b128 v95, v[56:59]
  s_cmp_lg_u32 s38, 0
  s_cbranch_scc1 L_e1v
  v_mul_f32 v3, v48, v84
  v_mul_f32 v5, v49, v85
  v_exp_f32_e64 v3, v3 clamp
  v_exp_f32_e64 v5, v5 clamp
  v_fma_f32 v4, v48, v76, v92
  v_fma_f32 v6, v49, v77, v92
  v_max_f32 v4, v4, v92
  v_max_f32 v6, v6, v92
  v_add_f32 v48, v3, v4
  v_add_f32 v49, v5, v6
  v_mul_f32 v3, v50, v86
  v_mul_f32 v5, v51, v87
  v_exp_f32_e64 v3, v3 clamp
  v_exp_f32_e64 v5, v5 clamp
  v_fma_f32 v4, v50, v78, v92
  v_fma_f32 v6, v51, v79, v92
  v_max_f32 v4, v4, v92
  v_max_f32 v6, v6, v92
  v_add_f32 v50, v3, v4
  v_add_f32 v51, v5, v6
  v_mul_f32 v3, v52, v88
  v_mul_f32 v5, v53, v89
  v_exp_f32_e64 v3, v3 clamp
  v_exp_f32_e64 v5, v5 clamp
  v_fma_f32 v4, v52, v80, v92
  v_fma_f32 v6, v53, v81, v92
  v_max_f32 v4, v4, v92
  v_max_f32 v6, v6, v92
  v_add_f32 v52, v3, v4
  v_add_f32 v53, v5, v6
  v_mul_f32 v3, v54, v90
  v_mul_f32 v5, v55, v91
  v_exp_f32_e64 v3, v3 clamp
  v_exp_f32_e64 v5, v5 clamp
  v_fma_f32 v4, v54, v82, v92
  v_fma_f32 v6, v55, v83, v92
  v_max_f32 v4, v4, v92
  v_max_f32 v6, v6, v92
  v_add_f32 v54, v3, v4
  v_add_f32 v55, v5, v6
  s_mov_b32 s66, 0x00ff00ff
  s_mov_b32 s67, 0x00ff00ff
  v_cndmask_b32 v48, 0, v48, s[66:67]
  v_cndmask_b32 v49, 0, v49, s[66:67]
  v_cndmask_b32 v50, 0, v50, s[66:67]
  v_cndmask_b32 v51, 0, v51, s[66:67]
  v_cndmask_b32 v52, 0, v52, s[66:67]
  v_cndmask_b32 v53, 0, v53, s[66:67]
  v_cndmask_b32 v54, 0, v54, s[66:67]
  v_cndmask_b32 v55, 0, v55, s[66:67]
  v_cvt_pk_bf16_f32 v48, v48, v49
  v_cvt_pk_bf16_f32 v49, v50, v51
  v_cvt_pk_bf16_f32 v50, v52, v53
  v_cvt_pk_bf16_f32 v51, v54, v55
  ds_write_b64 v94, v[48:49] offset:0
  ds_write_b64 v94, v[50:51] offset:512
  s_branch L_e1d
L_e1v:
  v_mul_f32 v48, v48, v76
  v_mul_f32 v49, v49, v77
  v_mul_f32 v50, v50, v78
  v_mul_f32 v51, v51, v79
  v_mul_f32 v52, v52, v80
  v_mul_f32 v53, v53, v81
  v_mul_f32 v54, v54, v82
  v_mul_f32 v55, v55, v83
  v_cvt_pk_bf16_f32 v48, v48, v49
  v_cvt_pk_bf16_f32 v49, v50, v51
  v_cvt_pk_bf16_f32 v50, v52, v53
  v_cvt_pk_bf16_f32 v51, v54, v55
  ds_write_b128 v94, v[48:51]
L_e1d:
  s_waitcnt vmcnt(10)
  s_mov_b32 s45, 0x1010101
  v_and_b32 v4, s45, v110
  v_cmp_eq_u32 vcc, s45, v4
  s_nop 1
  s_cmp_eq_u64 vcc, exec
  s_cbranch_scc1 L_pz_done
  v_and_b32 v3, 7, v0
  v_lshlrev_b32 v3, 2, v3
  s_lshl_b32 s44, s39, 5
  v_add_u32 v3, s44, v3
  s_mov_b32 s46, 0
L_pz_loop:
  global_load_dword v4, v3, s[28:29] sc0 sc1
  s_waitcnt vmcnt(0)
  v_and_b32 v4, s45, v4
  v_cmp_eq_u32 vcc, s45, v4
  s_nop 1
  s_cmp_eq_u64 vcc, exec
  s_cbranch_scc1 L_pz_done
  s_add_u32 s46, s46, 1
  s_cmp_lt_u32 s46, 0x40000
  s_sleep 4
  s_cbranch_scc1 L_pz_loop
L_pz_done:
  s_waitcnt lgkmcnt(0)
  s_barrier
  ds_read_b128 v[48:51], v97 offset:16384
  ds_read_b128 v[64:67], v99 offset:16384
  ds_read_b128 v[52:55], v97 offset:26624
  ds_read_b128 v[68:71], v99 offset:26624
  ds_read_b128 v[56:59], v98 offset:16384
  ds_read_b128 v[72:75], v106 offset:16384
  ds_read_b128 v[60:63], v98 offset:26624
  ds_read_b128 v[16:19], v106 offset:26624
  s_min_u32 s44, s36, 4
  s_add_u32 s44, s44, 5
  s_lshl_b32 s44, s44, 10
  v_lshl_add_u32 v4, v0, 4, s44
  ds_read_b128 v[20:23], v4 offset:16384
  ds_read_b128 v[24:27], v4 offset:26624
  v_mov_b32 v28, 0x3f803f80
  v_mov_b32 v29, 0x3f803f80
  v_mov_b32 v30, 0x3f803f80
  v_mov_b32 v31, 0x3f803f80
  v_lshlrev_b32 v6, 2, v0
  v_mov_b32 v10, 0x7f000000
  s_mul_i32 s48, s39, 17408
  s_add_u32 s48, s48, 41943040
  s_waitcnt lgkmcnt(0)
  v_mfma_f32_16x16x32_bf16 v[32:35], v[48:51], v[64:67], 0
  v_mfma_f32_16x16x32_bf16 v[36:39], v[56:59], v[72:75], 0
  v_mfma_f32_16x16x32_bf16 v[100:103], v[28:31], v[20:23], 0
  v_mfma_f32_16x16x32_bf16 v[32:35], v[52:55], v[68:71], v[32:35]
  v_mfma_f32_16x16x32_bf16 v[36:39], v[60:63], v[16:19], v[36:39]
  v_mfma_f32_16x16x32_bf16 v[100:103], v[28:31], v[24:27], v[100:103]
  v_add_u32 v48, 0, v107
  v_add_u32 v49, 1, v107
  v_add_u32 v50, 2, v107
  v_add_u32 v51, 3, v107
  v_cmp_gt_u32 s[66:67], 18, v48
  v_cmp_gt_u32 s[68:69], 18, v49
  v_cmp_gt_u32 s[70:71], 18, v50
  v_cmp_gt_u32 s[72:73], 18, v51
  v_cndmask_b32 v48, v10, v6, s[66:67]
  v_cndmask_b32 v49, v10, v6, s[68:69]
  v_cndmask_b32 v50, v10, v6, s[70:71]
  v_cndmask_b32 v51, v10, v6, s[72:73]
  v_add_u32 v52, 0, v104
  v_add_u32 v53, 1, v104
  v_add_u32 v54, 2, v104
  v_add_u32 v55, 3, v104
  v_cmp_gt_u32 s[66:67], 18, v52
  v_cmp_gt_u32 s[68:69], 18, v53
  v_cmp_gt_u32 s[70:71], 18, v54
  v_cmp_gt_u32 s[72:73], 18, v55
  v_cndmask_b32 v52, v10, v6, s[66:67]
  v_cndmask_b32 v53, v10, v6, s[68:69]
  v_cndmask_b32 v54, v10, v6, s[70:71]
  v_cndmask_b32 v55, v10, v6, s[72:73]
  s_add_u32 s44, s48, s88
  buffer_atomic_add_f32 v32, v48, s[24:27], s44 offen offset:0
  buffer_atomic_add_f32 v33, v49, s[24:27], s44 offen offset:256
  buffer_atomic_add_f32 v34, v50, s[24:27], s44 offen offset:512
  buffer_atomic_add_f32 v35, v51, s[24:27], s44 offen offset:768
  s_add_u32 s44, s48, s88
  s_add_u32 s44, s44, 8192
  buffer_atomic_add_f32 v36, v52, s[24:27], s44 offen offset:0
  buffer_atomic_add_f32 v37, v53, s[24:27], s44 offen offset:256
  buffer_atomic_add_f32 v38, v54, s[24:27], s44 offen offset:512
  buffer_atomic_add_f32 v39, v55, s[24:27], s44 offen offset:768
  s_add_u32 s44, s48, 14336
  buffer_atomic_add_f32 v100, v105, s[24:27], s44 offen
  v_mul_f32 v3, v40, v84
  v_mul_f32 v5, v41, v85
  v_exp_f32_e64 v3, v3 clamp
  v_exp_f32_e64 v5, v5 clamp
  v_fma_f32 v4, v40, v76, v92
  v_fma_f32 v6, v41, v77, v92
  v_max_f32 v4, v4, v92
  v_max_f32 v6, v6, v92
  v_add_f32 v40, v3, v4
  v_add_f32 v41, v5, v6
  v_mul_f32 v3, v42, v86
  v_mul_f32 v5, v43, v87
  v_exp_f32_e64 v3, v3 clamp
  v_exp_f32_e64 v5, v5 clamp
  v_fma_f32 v4, v42, v78, v92
  v_fma_f32 v6, v43, v79, v92
  v_max_f32 v4, v4, v92
  v_max_f32 v6, v6, v92
  v_add_f32 v42, v3, v4
  v_add_f32 v43, v5, v6
  v_mul_f32 v3, v44, v88
  v_mul_f32 v5, v45, v89
  v_exp_f32_e64 v3, v3 clamp
  v_exp_f32_e64 v5, v5 clamp
  v_fma_f32 v4, v44, v80, v92
  v_fma_f32 v6, v45, v81, v92
  v_max_f32 v4, v4, v92
  v_max_f32 v6, v6, v92
  v_add_f32 v44, v3, v4
  v_add_f32 v45, v5, v6
  v_mul_f32 v3, v46, v90
  v_mul_f32 v5, v47, v91
  v_exp_f32_e64 v3, v3 clamp
  v_exp_f32_e64 v5, v5 clamp
  v_fma_f32 v4, v46, v82, v92
  v_fma_f32 v6, v47, v83, v92
  v_max_f32 v4, v4, v92
  v_max_f32 v6, v6, v92
  v_add_f32 v46, v3, v4
  v_add_f32 v47, v5, v6
  v_cvt_pk_bf16_f32 v40, v40, v41
  v_cvt_pk_bf16_f32 v41, v42, v43
  v_cvt_pk_bf16_f32 v42, v44, v45
  v_cvt_pk_bf16_f32 v43, v46, v47
  ds_write_b64 v93, v[40:41] offset:0
  ds_write_b64 v93, v[42:43] offset:512
  s_waitcnt lgkmcnt(0)
  s_barrier
  s_mov_b32 s86, 0x409d30fc
  v_lshrrev_b32 v3, 2, v1
  v_and_b32 v4, 2, v3
  v_and_b32 v5, 1, v2
  v_lshl_add_u32 v4, v5, 2, v4
  v_bfe_u32 v5, v0, 1, 1
  s_lshl_b32 s44, s38, 1
  v_or_b32 v5, s44, v5
  v_xor_b32 v4, v4, v5
  v_lshlrev_b32 v4, 4, v4
  v_lshl_add_u32 v3, v2, 3, v3
  v_lshl_add_u32 v3, v3, 7, v4
  v_and_b32 v4, 1, v0
  v_lshl_add_u32 v73, v4, 3, v3
  s_lshl_b32 s44, s38, 6
  v_lshl_add_u32 v75, v2, 4, s44
  ds_read_b128 v[76:79], v75 offset:0
  v_add_u32 v72, 53248, v73
  ds_read_b64_tr_b16 v[16:17], v72 offset:0
  ds_read_b64_tr_b16 v[18:19], v72 offset:512
  ds_read_b64_tr_b16 v[20:21], v72 offset:4096
  ds_read_b64_tr_b16 v[22:23], v72 offset:4608
  ds_read_b64_tr_b16 v[24:25], v72 offset:8192
  ds_read_b64_tr_b16 v[26:27], v72 offset:8704
  ds_read_b64_tr_b16 v[28:29], v72 offset:12288
  ds_read_b64_tr_b16 v[30:31], v72 offset:12800
  ds_read_b64_tr_b16 v[32:33], v72 offset:16384
  ds_read_b64_tr_b16 v[34:35], v72 offset:16896
  s_waitcnt lgkmcnt(6)
  v_mfma_f32_16x16x32_bf16 v[40:43], v[16:19], v[112:115], v[76:79]
  s_add_u32 m0, s88, 16256
  ds_read_b64_tr_b16 v[36:37], v72 offset:20480
  buffer_load_dwordx4 v12, s[12:15], s55 offen offset:128 lds
  v_mfma_f32_16x16x32_bf16 v[44:47], v[16:19], v[184:187], v[76:79]
  ds_read_b64_tr_b16 v[38:39], v72 offset:20992
  v_mfma_f32_16x16x32_bf16 v[40:43], v[20:23], v[116:119], v[40:43]
  s_add_u32 m0, s88, 24448
  ds_read_b64_tr_b16 v[16:17], v72 offset:24576
  buffer_load_dwordx4 v12, s[12:15], s56 offen offset:128 lds
  v_mfma_f32_16x16x32_bf16 v[44:47], v[20:23], v[188:191], v[44:47]
  ds_read_b64_tr_b16 v[18:19], v72 offset:25088
  s_waitcnt lgkmcnt(6)
  v_mfma_f32_16x16x32_bf16 v[40:43], v[24:27], v[120:123], v[40:43]
  s_add_u32 m0, s88, 32640
  ds_read_b64_tr_b16 v[20:21], v72 offset:28672
  buffer_load_dwordx4 v12, s[12:15], s57 offen offset:128 lds
  v_mfma_f32_16x16x32_bf16 v[44:47], v[24:27], v[192:195], v[44:47]
  ds_read_b64_tr_b16 v[22:23], v72 offset:29184
  v_mfma_f32_16x16x32_bf16 v[40:43], v[28:31], v[124:127], v[40:43]
  ds_read_b64_tr_b16 v[24:25], v72 offset:32768
  v_mfma_f32_16x16x32_bf16 v[44:47], v[28:31], v[196:199], v[44:47]
  s_add_u32 m0, s88, 40832
  ds_read_b64_tr_b16 v[26:27], v72 offset:33280
  buffer_load_dwordx4 v12, s[12:15], s58 offen offset:128 lds
  s_waitcnt lgkmcnt(6)
  v_mfma_f32_16x16x32_bf16 v[40:43], v[32:35], v[128:131], v[40:43]
  v_mfma_f32_16x16x32_bf16 v[44:47], v[32:35], v[200:203], v[44:47]
  s_add_u32 m0, s88, 49024
  s_cmp_eq_u32 s37, 1
  s_cselect_b64 vcc, -1, 0
  s_cbranch_vccnz L_d13
  buffer_load_dwordx4 v12, s[12:15], s59 offen offset:128 lds
L_d13:
  v_mfma_f32_16x16x32_bf16 v[40:43], v[36:39], v[132:135], v[40:43]
  v_mfma_f32_16x16x32_bf16 v[44:47], v[36:39], v[204:207], v[44:47]
  s_waitcnt lgkmcnt(0)
  s_waitcnt vmcnt(19)
  s_barrier
  v_add_u32 v72, 90112, v73
  v_mfma_f32_16x16x32_bf16 v[40:43], v[16:19], v[136:139], v[40:43]
  ds_read_b64_tr_b16 v[28:29], v72 offset:0
  ds_read_b64_tr_b16 v[30:31], v72 offset:512
  v_mfma_f32_16x16x32_bf16 v[44:47], v[16:19], v[208:211], v[44:47]
  ds_read_b64_tr_b16 v[32:33], v72 offset:4096
  ds_read_b64_tr_b16 v[34:35], v72 offset:4608
  v_mfma_f32_16x16x32_bf16 v[40:43], v[20:23], v[140:143], v[40:43]
  ds_read_b64_tr_b16 v[36:37], v72 offset:8192
  ds_read_b64_tr_b16 v[38:39], v72 offset:8704
  v_mfma_f32_16x16x32_bf16 v[44:47], v[20:23], v[212:215], v[44:47]
  ds_read_b64_tr_b16 v[16:17], v72 offset:12288
  s_waitcnt lgkmcnt(5)
  v_mfma_f32_16x16x32_bf16 v[40:43], v[24:27], v[144:147], v[40:43]
  ds_read_b64_tr_b16 v[18:19], v72 offset:12800
  v_mfma_f32_16x16x32_bf16 v[44:47], v[24:27], v[216:219], v[44:47]
  ds_read_b64_tr_b16 v[20:21], v72 offset:16384
  v_mfma_f32_16x16x32_bf16 v[40:43], v[28:31], v[148:151], v[40:43]
  s_add_u32 m0, s88, 52992
  ds_read_b64_tr_b16 v[22:23], v72 offset:16896
  buffer_load_dwordx4 v12, s[12:15], s50 offen offset:256 lds
  v_mfma_f32_16x16x32_bf16 v[44:47], v[28:31], v[220:223], v[44:47]
  ds_read_b64_tr_b16 v[24:25], v72 offset:20480
  s_waitcnt lgkmcnt(5)
  v_mfma_f32_16x16x32_bf16 v[40:43], v[32:35], v[152:155], v[40:43]
  s_add_u32 m0, s88, 61184
  ds_read_b64_tr_b16 v[26:27], v72 offset:20992
  buffer_load_dwordx4 v12, s[12:15], s51 offen offset:256 lds
  v_mfma_f32_16x16x32_bf16 v[44:47], v[32:35], v[224:227], v[44:47]
  ds_read_b64_tr_b16 v[28:29], v72 offset:24576
  v_mfma_f32_16x16x32_bf16 v[40:43], v[36:39], v[156:159], v[40:43]
  s_add_u32 m0, s88, 69376
  ds_read_b64_tr_b16 v[30:31], v72 offset:25088
  buffer_load_dwordx4 v12, s[12:15], s52 offen offset:256 lds
  v_mfma_f32_16x16x32_bf16 v[44:47], v[36:39], v[228:231], v[44:47]
  ds_read_b64_tr_b16 v[32:33], v72 offset:28672
  s_waitcnt lgkmcnt(5)
  v_mfma_f32_16x16x32_bf16 v[40:43], v[16:19], v[160:163], v[40:43]
  ds_read_b128 v[80:83], v75 offset:256
  ds_read_b64_tr_b16 v[34:35], v72 offset:29184
  v_mfma_f32_16x16x32_bf16 v[44:47], v[16:19], v[232:235], v[44:47]
  s_add_u32 m0, s88, 77568
  ds_read_b64_tr_b16 v[36:37], v72 offset:32768
  buffer_load_dwordx4 v12, s[12:15], s53 offen offset:256 lds
  v_mfma_f32_16x16x32_bf16 v[40:43], v[20:23], v[164:167], v[40:43]
  ds_read_b64_tr_b16 v[38:39], v72 offset:33280
  v_mfma_f32_16x16x32_bf16 v[44:47], v[20:23], v[236:239], v[44:47]
  s_add_u32 m0, s88, 85760
  s_cbranch_vccnz L_d14
  buffer_load_dwordx4 v12, s[12:15], s54 offen offset:256 lds
L_d14:
  s_waitcnt lgkmcnt(5)
  v_mfma_f32_16x16x32_bf16 v[40:43], v[24:27], v[168:171], v[40:43]
  v_mfma_f32_16x16x32_bf16 v[44:47], v[24:27], v[240:243], v[44:47]
  s_waitcnt lgkmcnt(0)
  s_waitcnt vmcnt(19)
  s_barrier
  v_add_u32 v72, 126976, v73
  v_mfma_f32_16x16x32_bf16 v[40:43], v[28:31], v[172:175], v[40:43]
  ds_read_b64_tr_b16 v[16:17], v72 offset:0
  ds_read_b64_tr_b16 v[18:19], v72 offset:512
  v_mfma_f32_16x16x32_bf16 v[44:47], v[28:31], v[244:247], v[44:47]
  ds_read_b64_tr_b16 v[20:21], v72 offset:4096
  ds_read_b64_tr_b16 v[22:23], v72 offset:4608
  v_mfma_f32_16x16x32_bf16 v[40:43], v[32:35], v[176:179], v[40:43]
  ds_read_b64_tr_b16 v[24:25], v72 offset:8192
  ds_read_b64_tr_b16 v[26:27], v72 offset:8704
  v_mfma_f32_16x16x32_bf16 v[44:47], v[32:35], v[248:251], v[44:47]
  ds_read_b64_tr_b16 v[28:29], v72 offset:12288
  v_mfma_f32_16x16x32_bf16 v[40:43], v[36:39], v[180:183], v[40:43]
  ds_read_b64_tr_b16 v[30:31], v72 offset:12800
  v_mfma_f32_16x16x32_bf16 v[44:47], v[36:39], v[252:255], v[44:47]
  ds_read_b64_tr_b16 v[32:33], v72 offset:16384
  s_waitcnt lgkmcnt(5)
  v_mfma_f32_16x16x32_bf16 v[48:51], v[16:19], v[112:115], v[80:83]
  s_add_u32 m0, s88, 89856
  ds_read_b64_tr_b16 v[34:35], v72 offset:16896
  buffer_load_dwordx4 v12, s[12:15], s55 offen offset:256 lds
  v_mfma_f32_16x16x32_bf16 v[52:55], v[16:19], v[184:187], v[80:83]
  ds_read_b64_tr_b16 v[36:37], v72 offset:20480
  v_mfma_f32_16x16x32_bf16 v[48:51], v[20:23], v[116:119], v[48:51]
  s_add_u32 m0, s88, 98048
  v_fma_f32 v3, v40, v40, s86
  v_fma_f32 v4, v41, v41, s86
  ds_read_b64_tr_b16 v[38:39], v72 offset:20992
  buffer_load_dwordx4 v12, s[12:15], s56 offen offset:256 lds
  v_mfma_f32_16x16x32_bf16 v[52:55], v[20:23], v[188:191], v[52:55]
  v_mul_f32 v3, -v40, v3
  v_mul_f32 v4, -v41, v4
  ds_read_b64_tr_b16 v[16:17], v72 offset:24576
  s_waitcnt lgkmcnt(5)
  v_mfma_f32_16x16x32_bf16 v[48:51], v[24:27], v[120:123], v[48:51]
  s_add_u32 m0, s88, 106240
  v_exp_f32 v3, v3
  ds_read_b64_tr_b16 v[18:19], v72 offset:25088
  buffer_load_dwordx4 v12, s[12:15], s57 offen offset:256 lds
  v_mfma_f32_16x16x32_bf16 v[52:55], v[24:27], v[192:195], v[52:55]
  v_exp_f32 v4, v4
  ds_read_b64_tr_b16 v[20:21], v72 offset:28672
  v_mfma_f32_16x16x32_bf16 v[48:51], v[28:31], v[124:127], v[48:51]
  v_add_f32 v3, 1.0, v3
  v_add_f32 v4, 1.0, v4
  ds_read_b64_tr_b16 v[22:23], v72 offset:29184
  v_mfma_f32_16x16x32_bf16 v[52:55], v[28:31], v[196:199], v[52:55]
  s_add_u32 m0, s88, 114432
  v_rcp_f32 v3, v3
  ds_read_b64_tr_b16 v[24:25], v72 offset:32768
  buffer_load_dwordx4 v12, s[12:15], s58 offen offset:256 lds
  s_waitcnt lgkmcnt(5)
  v_mfma_f32_16x16x32_bf16 v[48:51], v[32:35], v[128:131], v[48:51]
  v_rcp_f32 v4, v4
  ds_read_b64_tr_b16 v[26:27], v72 offset:33280
  v_mfma_f32_16x16x32_bf16 v[52:55], v[32:35], v[200:203], v[52:55]
  s_add_u32 m0, s88, 122624
  v_mul_f32 v3, v3, v40
  v_mul_f32 v4, v4, v41
  s_cbranch_vccnz L_d15
  buffer_load_dwordx4 v12, s[12:15], s59 offen offset:256 lds
L_d15:
  v_mfma_f32_16x16x32_bf16 v[48:51], v[36:39], v[132:135], v[48:51]
  v_fma_f32 v7, v42, v42, s86
  v_fma_f32 v8, v43, v43, s86
  v_mfma_f32_16x16x32_bf16 v[52:55], v[36:39], v[204:207], v[52:55]
  v_mul_f32 v7, -v42, v7
  v_mul_f32 v8, -v43, v8
  s_waitcnt lgkmcnt(0)
  s_waitcnt vmcnt(8)
  s_barrier
  v_add_u32 v72, 16384, v73
  s_cmp_lg_u32 s36, 0
  s_cbranch_scc1 L_nosig
  s_lshl_b32 s44, s39, 5
  s_add_u32 s44, s44, s40
  v_mov_b32 v9, s44
  v_mov_b32 v10, 3
  s_mov_b64 s[82:83], exec
  s_mov_b64 exec, 1
  global_store_byte v9, v10, s[28:29] sc0 sc1
  s_mov_b64 exec, s[82:83]
L_nosig:
  s_nop 0
  v_mfma_f32_16x16x32_bf16 v[48:51], v[16:19], v[136:139], v[48:51]
  v_exp_f32 v7, v7
  ds_read_b64_tr_b16 v[28:29], v72 offset:0
  ds_read_b64_tr_b16 v[30:31], v72 offset:512
  v_mfma_f32_16x16x32_bf16 v[52:55], v[16:19], v[208:211], v[52:55]
  v_exp_f32 v8, v8
  ds_read_b64_tr_b16 v[32:33], v72 offset:4096
  ds_read_b64_tr_b16 v[34:35], v72 offset:4608
  v_mfma_f32_16x16x32_bf16 v[48:51], v[20:23], v[140:143], v[48:51]
  v_add_f32 v7, 1.0, v7
  v_add_f32 v8, 1.0, v8
  ds_read_b64_tr_b16 v[36:37], v72 offset:8192
  ds_read_b64_tr_b16 v[38:39], v72 offset:8704
  v_mfma_f32_16x16x32_bf16 v[52:55], v[20:23], v[212:215], v[52:55]
  v_rcp_f32 v7, v7
  ds_read_b64_tr_b16 v[16:17], v72 offset:12288
  s_waitcnt lgkmcnt(5)
  v_mfma_f32_16x16x32_bf16 v[48:51], v[24:27], v[144:147], v[48:51]
  v_rcp_f32 v8, v8
  ds_read_b64_tr_b16 v[18:19], v72 offset:12800
  v_mfma_f32_16x16x32_bf16 v[52:55], v[24:27], v[216:219], v[52:55]
  v_mul_f32 v7, v7, v42
  v_mul_f32 v8, v8, v43
  ds_read_b64_tr_b16 v[20:21], v72 offset:16384
  v_mfma_f32_16x16x32_bf16 v[48:51], v[28:31], v[148:151], v[48:51]
  s_add_u32 m0, s88, 126592
  v_cvt_pk_bf16_f32 v56, v3, v4
  v_cvt_pk_bf16_f32 v57, v7, v8
  ds_read_b64_tr_b16 v[22:23], v72 offset:16896
  buffer_load_dwordx4 v12, s[12:15], s50 offen offset:384 lds
  v_mfma_f32_16x16x32_bf16 v[52:55], v[28:31], v[220:223], v[52:55]
  v_fma_f32 v3, v44, v44, s86
  v_fma_f32 v4, v45, v45, s86
  ds_read_b64_tr_b16 v[24:25], v72 offset:20480
  s_waitcnt lgkmcnt(5)
  v_mfma_f32_16x16x32_bf16 v[48:51], v[32:35], v[152:155], v[48:51]
  s_add_u32 m0, s88, 134784
  v_mul_f32 v3, -v44, v3
  v_mul_f32 v4, -v45, v4
  ds_read_b64_tr_b16 v[26:27], v72 offset:20992
  buffer_load_dwordx4 v12, s[12:15], s51 offen offset:384 lds
  v_mfma_f32_16x16x32_bf16 v[52:55], v[32:35], v[224:227], v[52:55]
  v_exp_f32 v3, v3
  ds_read_b64_tr_b16 v[28:29], v72 offset:24576
  v_mfma_f32_16x16x32_bf16 v[48:51], v[36:39], v[156:159], v[48:51]
  s_add_u32 m0, s88, 142976
  v_exp_f32 v4, v4
  ds_read_b64_tr_b16 v[30:31], v72 offset:25088
  buffer_load_dwordx4 v12, s[12:15], s52 offen offset:384 lds
  v_mfma_f32_16x16x32_bf16 v[52:55], v[36:39], v[228:231], v[52:55]
  v_add_f32 v3, 1.0, v3
  v_add_f32 v4, 1.0, v4
  ds_read_b64_tr_b16 v[32:33], v72 offset:28672
  s_waitcnt lgkmcnt(5)
  v_mfma_f32_16x16x32_bf16 v[48:51], v[16:19], v[160:163], v[48:51]
  v_rcp_f32 v3, v3
  ds_read_b128 v[76:79], v75 offset:512
  ds_read_b64_tr_b16 v[34:35], v72 offset:29184
  v_mfma_f32_16x16x32_bf16 v[52:55], v[16:19], v[232:235], v[52:55]
  s_add_u32 m0, s88, 151168
  v_rcp_f32 v4, v4
  ds_read_b64_tr_b16 v[36:37], v72 offset:32768
  buffer_load_dwordx4 v12, s[12:15], s53 offen offset:384 lds
  v_mfma_f32_16x16x32_bf16 v[48:51], v[20:23], v[164:167], v[48:51]
  v_mul_f32 v3, v3, v44
  v_mul_f32 v4, v4, v45
  ds_read_b64_tr_b16 v[38:39], v72 offset:33280
  v_mfma_f32_16x16x32_bf16 v[52:55], v[20:23], v[236:239], v[52:55]
  s_add_u32 m0, s88, 159360
  v_fma_f32 v7, v46, v46, s86
  v_fma_f32 v8, v47, v47, s86
  s_cbranch_vccnz L_d16
  buffer_load_dwordx4 v12, s[12:15], s54 offen offset:384 lds
L_d16:
  s_waitcnt lgkmcnt(5)
  v_mfma_f32_16x16x32_bf16 v[48:51], v[24:27], v[168:171], v[48:51]
  v_mul_f32 v7, -v46, v7
  v_mul_f32 v8, -v47, v8
  v_mfma_f32_16x16x32_bf16 v[52:55], v[24:27], v[240:243], v[52:55]
  v_exp_f32 v7, v7
  s_waitcnt lgkmcnt(0)
  s_waitcnt vmcnt(8)
  s_barrier
  v_add_u32 v72, 53248, v73
  v_mfma_f32_16x16x32_bf16 v[48:51], v[28:31], v[172:175], v[48:51]
  v_exp_f32 v8, v8
  ds_read_b64_tr_b16 v[16:17], v72 offset:0
  ds_read_b64_tr_b16 v[18:19], v72 offset:512
  v_mfma_f32_16x16x32_bf16 v[52:55], v[28:31], v[244:247], v[52:55]
  v_add_f32 v7, 1.0, v7
  v_add_f32 v8, 1.0, v8
  ds_read_b64_tr_b16 v[20:21], v72 offset:4096
  ds_read_b64_tr_b16 v[22:23], v72 offset:4608
  v_mfma_f32_16x16x32_bf16 v[48:51], v[32:35], v[176:179], v[48:51]
  v_rcp_f32 v7, v7
  ds_read_b64_tr_b16 v[24:25], v72 offset:8192
  ds_read_b64_tr_b16 v[26:27], v72 offset:8704
  v_mfma_f32_16x16x32_bf16 v[52:55], v[32:35], v[248:251], v[52:55]
  v_rcp_f32 v8, v8
  ds_read_b64_tr_b16 v[28:29], v72 offset:12288
  v_mfma_f32_16x16x32_bf16 v[48:51], v[36:39], v[180:183], v[48:51]
  v_mul_f32 v7, v7, v46
  v_mul_f32 v8, v8, v47
  ds_read_b64_tr_b16 v[30:31], v72 offset:12800
  v_mfma_f32_16x16x32_bf16 v[52:55], v[36:39], v[252:255], v[52:55]
  v_cvt_pk_bf16_f32 v58, v3, v4
  v_cvt_pk_bf16_f32 v59, v7, v8
  ds_read_b64_tr_b16 v[32:33], v72 offset:16384
  s_waitcnt lgkmcnt(5)
  v_mfma_f32_16x16x32_bf16 v[40:43], v[16:19], v[112:115], v[76:79]
  s_add_u32 m0, s88, 16000
  ds_read_b64_tr_b16 v[34:35], v72 offset:16896
  buffer_load_dwordx4 v12, s[12:15], s55 offen offset:384 lds
  v_mfma_f32_16x16x32_bf16 v[44:47], v[16:19], v[184:187], v[76:79]
  ds_read_b64_tr_b16 v[36:37], v72 offset:20480
  v_mfma_f32_16x16x32_bf16 v[40:43], v[20:23], v[116:119], v[40:43]
  s_add_u32 m0, s88, 24192
  v_fma_f32 v3, v48, v48, s86
  v_fma_f32 v4, v49, v49, s86
  ds_read_b64_tr_b16 v[38:39], v72 offset:20992
  buffer_load_dwordx4 v12, s[12:15], s56 offen offset:384 lds
  v_mfma_f32_16x16x32_bf16 v[44:47], v[20:23], v[188:191], v[44:47]
  v_mul_f32 v3, -v48, v3
  v_mul_f32 v4, -v49, v4
  ds_read_b64_tr_b16 v[16:17], v72 offset:24576
  s_waitcnt lgkmcnt(5)
  v_mfma_f32_16x16x32_bf16 v[40:43], v[24:27], v[120:123], v[40:43]
  s_add_u32 m0, s88, 32384
  v_exp_f32 v3, v3
  ds_read_b64_tr_b16 v[18:19], v72 offset:25088
  buffer_load_dwordx4 v12, s[12:15], s57 offen offset:384 lds
  v_mfma_f32_16x16x32_bf16 v[44:47], v[24:27], v[192:195], v[44:47]
  v_exp_f32 v4, v4
  ds_read_b64_tr_b16 v[20:21], v72 offset:28672
  v_mfma_f32_16x16x32_bf16 v[40:43], v[28:31], v[124:127], v[40:43]
  v_add_f32 v3, 1.0, v3
  v_add_f32 v4, 1.0, v4
  ds_read_b64_tr_b16 v[22:23], v72 offset:29184
  v_mfma_f32_16x16x32_bf16 v[44:47], v[28:31], v[196:199], v[44:47]
  s_add_u32 m0, s88, 40576
  v_rcp_f32 v3, v3
  ds_read_b64_tr_b16 v[24:25], v72 offset:32768
  buffer_load_dwordx4 v12, s[12:15], s58 offen offset:384 lds
  s_waitcnt lgkmcnt(5)
  v_mfma_f32_16x16x32_bf16 v[40:43], v[32:35], v[128:131], v[40:43]
  v_rcp_f32 v4, v4
  ds_read_b64_tr_b16 v[26:27], v72 offset:33280
  v_mfma_f32_16x16x32_bf16 v[44:47], v[32:35], v[200:203], v[44:47]
  s_add_u32 m0, s88, 48768
  v_mul_f32 v3, v3, v48
  v_mul_f32 v4, v4, v49
  s_cbranch_vccnz L_d17
  buffer_load_dwordx4 v12, s[12:15], s59 offen offset:384 lds
L_d17:
  v_mfma_f32_16x16x32_bf16 v[40:43], v[36:39], v[132:135], v[40:43]
  v_fma_f32 v7, v50, v50, s86
  v_fma_f32 v8, v51, v51, s86
  v_mfma_f32_16x16x32_bf16 v[44:47], v[36:39], v[204:207], v[44:47]
  v_mul_f32 v7, -v50, v7
  v_mul_f32 v8, -v51, v8
  s_waitcnt lgkmcnt(0)
  s_waitcnt vmcnt(8)
  s_barrier
  v_add_u32 v72, 90112, v73
  v_mfma_f32_16x16x32_bf16 v[40:43], v[16:19], v[136:139], v[40:43]
  v_exp_f32 v7, v7
  ds_read_b64_tr_b16 v[28:29], v72 offset:0
  ds_read_b64_tr_b16 v[30:31], v72 offset:512
  v_mfma_f32_16x16x32_bf16 v[44:47], v[16:19], v[208:211], v[44:47]
  v_exp_f32 v8, v8
  ds_read_b64_tr_b16 v[32:33], v72 offset:4096
  ds_read_b64_tr_b16 v[34:35], v72 offset:4608
  v_mfma_f32_16x16x32_bf16 v[40:43], v[20:23], v[140:143], v[40:43]
  v_add_f32 v7, 1.0, v7
  v_add_f32 v8, 1.0, v8
  ds_read_b64_tr_b16 v[36:37], v72 offset:8192
  ds_read_b64_tr_b16 v[38:39], v72 offset:8704
  v_mfma_f32_16x16x32_bf16 v[44:47], v[20:23], v[212:215], v[44:47]
  v_rcp_f32 v7, v7
  ds_read_b64_tr_b16 v[16:17], v72 offset:12288
  s_waitcnt lgkmcnt(5)
  v_mfma_f32_16x16x32_bf16 v[40:43], v[24:27], v[144:147], v[40:43]
  v_rcp_f32 v8, v8
  ds_read_b64_tr_b16 v[18:19], v72 offset:12800
  v_mfma_f32_16x16x32_bf16 v[44:47], v[24:27], v[216:219], v[44:47]
  v_mul_f32 v7, v7, v50
  v_mul_f32 v8, v8, v51
  ds_read_b64_tr_b16 v[20:21], v72 offset:16384
  v_mfma_f32_16x16x32_bf16 v[40:43], v[28:31], v[148:151], v[40:43]
  s_add_u32 m0, s88, 52736
  v_cvt_pk_bf16_f32 v60, v3, v4
  v_cvt_pk_bf16_f32 v61, v7, v8
  ds_read_b64_tr_b16 v[22:23], v72 offset:16896
  buffer_load_dwordx4 v12, s[12:15], s50 offen offset:512 lds
  v_mfma_f32_16x16x32_bf16 v[44:47], v[28:31], v[220:223], v[44:47]
  v_fma_f32 v3, v52, v52, s86
  v_fma_f32 v4, v53, v53, s86
  ds_read_b64_tr_b16 v[24:25], v72 offset:20480
  s_waitcnt lgkmcnt(5)
  v_mfma_f32_16x16x32_bf16 v[40:43], v[32:35], v[152:155], v[40:43]
  s_add_u32 m0, s88, 60928
  v_mul_f32 v3, -v52, v3
  v_mul_f32 v4, -v53, v4
  ds_read_b64_tr_b16 v[26:27], v72 offset:20992
  buffer_load_dwordx4 v12, s[12:15], s51 offen offset:512 lds
  v_mfma_f32_16x16x32_bf16 v[44:47], v[32:35], v[224:227], v[44:47]
  v_exp_f32 v3, v3
  ds_read_b64_tr_b16 v[28:29], v72 offset:24576
  v_mfma_f32_16x16x32_bf16 v[40:43], v[36:39], v[156:159], v[40:43]
  s_add_u32 m0, s88, 69120
  v_exp_f32 v4, v4
  ds_read_b64_tr_b16 v[30:31], v72 offset:25088
  buffer_load_dwordx4 v12, s[12:15], s52 offen offset:512 lds
  v_mfma_f32_16x16x32_bf16 v[44:47], v[36:39], v[228:231], v[44:47]
  v_add_f32 v3, 1.0, v3
  v_add_f32 v4, 1.0, v4
  ds_read_b64_tr_b16 v[32:33], v72 offset:28672
  s_waitcnt lgkmcnt(5)
  v_mfma_f32_16x16x32_bf16 v[40:43], v[16:19], v[160:163], v[40:43]
  v_rcp_f32 v3, v3
  ds_read_b128 v[80:83], v75 offset:768
  ds_read_b64_tr_b16 v[34:35], v72 offset:29184
  v_mfma_f32_16x16x32_bf16 v[44:47], v[16:19], v[232:235], v[44:47]
  s_add_u32 m0, s88, 77312
  v_rcp_f32 v4, v4
  ds_read_b64_tr_b16 v[36:37], v72 offset:32768
  buffer_load_dwordx4 v12, s[12:15], s53 offen offset:512 lds
  v_mfma_f32_16x16x32_bf16 v[40:43], v[20:23], v[164:167], v[40:43]
  v_mul_f32 v3, v3, v52
  v_mul_f32 v4, v4, v53
  ds_read_b64_tr_b16 v[38:39], v72 offset:33280
  v_mfma_f32_16x16x32_bf16 v[44:47], v[20:23], v[236:239], v[44:47]
  s_add_u32 m0, s88, 85504
  v_fma_f32 v7, v54, v54, s86
  v_fma_f32 v8, v55, v55, s86
  s_cbranch_vccnz L_d18
  buffer_load_dwordx4 v12, s[12:15], s54 offen offset:512 lds
L_d18:
  s_waitcnt lgkmcnt(5)
  v_mfma_f32_16x16x32_bf16 v[40:43], v[24:27], v[168:171], v[40:43]
  v_mul_f32 v7, -v54, v7
  v_mul_f32 v8, -v55, v8
  v_mfma_f32_16x16x32_bf16 v[44:47], v[24:27], v[240:243], v[44:47]
  v_exp_f32 v7, v7
  s_waitcnt lgkmcnt(0)
  s_waitcnt vmcnt(8)
  s_barrier
  v_add_u32 v72, 126976, v73
  v_mfma_f32_16x16x32_bf16 v[40:43], v[28:31], v[172:175], v[40:43]
  v_exp_f32 v8, v8
  ds_read_b64_tr_b16 v[16:17], v72 offset:0
  ds_read_b64_tr_b16 v[18:19], v72 offset:512
  v_mfma_f32_16x16x32_bf16 v[44:47], v[28:31], v[244:247], v[44:47]
  v_add_f32 v7, 1.0, v7
  v_add_f32 v8, 1.0, v8
  ds_read_b64_tr_b16 v[20:21], v72 offset:4096
  ds_read_b64_tr_b16 v[22:23], v72 offset:4608
  v_mfma_f32_16x16x32_bf16 v[40:43], v[32:35], v[176:179], v[40:43]
  v_rcp_f32 v7, v7
  ds_read_b64_tr_b16 v[24:25], v72 offset:8192
  ds_read_b64_tr_b16 v[26:27], v72 offset:8704
  v_mfma_f32_16x16x32_bf16 v[44:47], v[32:35], v[248:251], v[44:47]
  v_rcp_f32 v8, v8
  ds_read_b64_tr_b16 v[28:29], v72 offset:12288
  v_mfma_f32_16x16x32_bf16 v[40:43], v[36:39], v[180:183], v[40:43]
  v_mul_f32 v7, v7, v54
  v_mul_f32 v8, v8, v55
  ds_read_b64_tr_b16 v[30:31], v72 offset:12800
  v_mfma_f32_16x16x32_bf16 v[44:47], v[36:39], v[252:255], v[44:47]
  v_cvt_pk_bf16_f32 v62, v3, v4
  v_cvt_pk_bf16_f32 v63, v7, v8
  ds_read_b64_tr_b16 v[32:33], v72 offset:16384
  s_waitcnt lgkmcnt(5)
  v_mfma_f32_16x16x32_bf16 v[48:51], v[16:19], v[112:115], v[80:83]
  s_add_u32 m0, s88, 89600
  ds_read_b64_tr_b16 v[34:35], v72 offset:16896
  buffer_load_dwordx4 v12, s[12:15], s55 offen offset:512 lds
  v_mfma_f32_16x16x32_bf16 v[52:55], v[16:19], v[184:187], v[80:83]
  ds_read_b64_tr_b16 v[36:37], v72 offset:20480
  v_mfma_f32_16x16x32_bf16 v[48:51], v[20:23], v[116:119], v[48:51]
  s_add_u32 m0, s88, 97792
  v_fma_f32 v3, v40, v40, s86
  v_fma_f32 v4, v41, v41, s86
  ds_read_b64_tr_b16 v[38:39], v72 offset:20992
  buffer_load_dwordx4 v12, s[12:15], s56 offen offset:512 lds
  v_mfma_f32_16x16x32_bf16 v[52:55], v[20:23], v[188:191], v[52:55]
  v_mul_f32 v3, -v40, v3
  v_mul_f32 v4, -v41, v4
  ds_read_b64_tr_b16 v[16:17], v72 offset:24576
  s_waitcnt lgkmcnt(5)
  v_mfma_f32_16x16x32_bf16 v[48:51], v[24:27], v[120:123], v[48:51]
  s_add_u32 m0, s88, 105984
  v_exp_f32 v3, v3
  ds_read_b64_tr_b16 v[18:19], v72 offset:25088
  buffer_load_dwordx4 v12, s[12:15], s57 offen offset:512 lds
  v_mfma_f32_16x16x32_bf16 v[52:55], v[24:27], v[192:195], v[52:55]
  v_exp_f32 v4, v4
  ds_read_b64_tr_b16 v[20:21], v72 offset:28672
  v_mfma_f32_16x16x32_bf16 v[48:51], v[28:31], v[124:127], v[48:51]
  v_add_f32 v3, 1.0, v3
  v_add_f32 v4, 1.0, v4
  ds_read_b64_tr_b16 v[22:23], v72 offset:29184
  v_mfma_f32_16x16x32_bf16 v[52:55], v[28:31], v[196:199], v[52:55]
  s_add_u32 m0, s88, 114176
  v_rcp_f32 v3, v3
  ds_read_b64_tr_b16 v[24:25], v72 offset:32768
  buffer_load_dwordx4 v12, s[12:15], s58 offen offset:512 lds
  s_waitcnt lgkmcnt(5)
  v_mfma_f32_16x16x32_bf16 v[48:51], v[32:35], v[128:131], v[48:51]
  v_rcp_f32 v4, v4
  ds_read_b64_tr_b16 v[26:27], v72 offset:33280
  v_mfma_f32_16x16x32_bf16 v[52:55], v[32:35], v[200:203], v[52:55]
  s_add_u32 m0, s88, 122368
  v_mul_f32 v3, v3, v40
  v_mul_f32 v4, v4, v41
  s_cbranch_vccnz L_d19
  buffer_load_dwordx4 v12, s[12:15], s59 offen offset:512 lds
L_d19:
  v_mfma_f32_16x16x32_bf16 v[48:51], v[36:39], v[132:135], v[48:51]
  v_fma_f32 v7, v42, v42, s86
  v_fma_f32 v8, v43, v43, s86
  v_mfma_f32_16x16x32_bf16 v[52:55], v[36:39], v[204:207], v[52:55]
  v_mul_f32 v7, -v42, v7
  v_mul_f32 v8, -v43, v8
  s_waitcnt lgkmcnt(0)
  s_waitcnt vmcnt(8)
  s_barrier
  v_add_u32 v72, 16384, v73
  v_mfma_f32_16x16x32_bf16 v[48:51], v[16:19], v[136:139], v[48:51]
  v_exp_f32 v7, v7
  ds_read_b64_tr_b16 v[28:29], v72 offset:0
  ds_read_b64_tr_b16 v[30:31], v72 offset:512
  v_mfma_f32_16x16x32_bf16 v[52:55], v[16:19], v[208:211], v[52:55]
  v_exp_f32 v8, v8
  ds_read_b64_tr_b16 v[32:33], v72 offset:4096
  ds_read_b64_tr_b16 v[34:35], v72 offset:4608
  v_mfma_f32_16x16x32_bf16 v[48:51], v[20:23], v[140:143], v[48:51]
  v_add_f32 v7, 1.0, v7
  v_add_f32 v8, 1.0, v8
  ds_read_b64_tr_b16 v[36:37], v72 offset:8192
  ds_read_b64_tr_b16 v[38:39], v72 offset:8704
  v_mfma_f32_16x16x32_bf16 v[52:55], v[20:23], v[212:215], v[52:55]
  v_rcp_f32 v7, v7
  ds_read_b64_tr_b16 v[16:17], v72 offset:12288
  s_waitcnt lgkmcnt(5)
  v_mfma_f32_16x16x32_bf16 v[48:51], v[24:27], v[144:147], v[48:51]
  v_rcp_f32 v8, v8
  ds_read_b64_tr_b16 v[18:19], v72 offset:12800
  v_mfma_f32_16x16x32_bf16 v[52:55], v[24:27], v[216:219], v[52:55]
  v_mul_f32 v7, v7, v42
  v_mul_f32 v8, v8, v43
  ds_read_b64_tr_b16 v[20:21], v72 offset:16384
  v_mfma_f32_16x16x32_bf16 v[48:51], v[28:31], v[148:151], v[48:51]
  s_add_u32 m0, s88, 126336
  v_cvt_pk_bf16_f32 v64, v3, v4
  v_cvt_pk_bf16_f32 v65, v7, v8
  ds_read_b64_tr_b16 v[22:23], v72 offset:16896
  buffer_load_dwordx4 v12, s[12:15], s50 offen offset:640 lds
  v_mfma_f32_16x16x32_bf16 v[52:55], v[28:31], v[220:223], v[52:55]
  v_fma_f32 v3, v44, v44, s86
  v_fma_f32 v4, v45, v45, s86
  ds_read_b64_tr_b16 v[24:25], v72 offset:20480
  s_waitcnt lgkmcnt(5)
  v_mfma_f32_16x16x32_bf16 v[48:51], v[32:35], v[152:155], v[48:51]
  s_add_u32 m0, s88, 134528
  v_mul_f32 v3, -v44, v3
  v_mul_f32 v4, -v45, v4
  ds_read_b64_tr_b16 v[26:27], v72 offset:20992
  buffer_load_dwordx4 v12, s[12:15], s51 offen offset:640 lds
  v_mfma_f32_16x16x32_bf16 v[52:55], v[32:35], v[224:227], v[52:55]
  v_exp_f32 v3, v3
  ds_read_b64_tr_b16 v[28:29], v72 offset:24576
  v_mfma_f32_16x16x32_bf16 v[48:51], v[36:39], v[156:159], v[48:51]
  s_add_u32 m0, s88, 142720
  v_exp_f32 v4, v4
  ds_read_b64_tr_b16 v[30:31], v72 offset:25088
  buffer_load_dwordx4 v12, s[12:15], s52 offen offset:640 lds
  v_mfma_f32_16x16x32_bf16 v[52:55], v[36:39], v[228:231], v[52:55]
  v_add_f32 v3, 1.0, v3
  v_add_f32 v4, 1.0, v4
  ds_read_b64_tr_b16 v[32:33], v72 offset:28672
  s_waitcnt lgkmcnt(5)
  v_mfma_f32_16x16x32_bf16 v[48:51], v[16:19], v[160:163], v[48:51]
  v_rcp_f32 v3, v3
  ds_read_b128 v[76:79], v75 offset:1024
  ds_read_b64_tr_b16 v[34:35], v72 offset:29184
  v_mfma_f32_16x16x32_bf16 v[52:55], v[16:19], v[232:235], v[52:55]
  s_add_u32 m0, s88, 150912
  v_rcp_f32 v4, v4
  ds_read_b64_tr_b16 v[36:37], v72 offset:32768
  buffer_load_dwordx4 v12, s[12:15], s53 offen offset:640 lds
  v_mfma_f32_16x16x32_bf16 v[48:51], v[20:23], v[164:167], v[48:51]
  v_mul_f32 v3, v3, v44
  v_mul_f32 v4, v4, v45
  ds_read_b64_tr_b16 v[38:39], v72 offset:33280
  v_mfma_f32_16x16x32_bf16 v[52:55], v[20:23], v[236:239], v[52:55]
  s_add_u32 m0, s88, 159104
  v_fma_f32 v7, v46, v46, s86
  v_fma_f32 v8, v47, v47, s86
  s_cbranch_vccnz L_d20
  buffer_load_dwordx4 v12, s[12:15], s54 offen offset:640 lds
L_d20:
  s_waitcnt lgkmcnt(5)
  v_mfma_f32_16x16x32_bf16 v[48:51], v[24:27], v[168:171], v[48:51]
  v_mul_f32 v7, -v46, v7
  v_mul_f32 v8, -v47, v8
  v_mfma_f32_16x16x32_bf16 v[52:55], v[24:27], v[240:243], v[52:55]
  v_exp_f32 v7, v7
  s_waitcnt lgkmcnt(0)
  s_waitcnt vmcnt(8)
  s_barrier
  v_add_u32 v72, 53248, v73
  v_mfma_f32_16x16x32_bf16 v[48:51], v[28:31], v[172:175], v[48:51]
  v_exp_f32 v8, v8
  ds_read_b64_tr_b16 v[16:17], v72 offset:0
  ds_read_b64_tr_b16 v[18:19], v72 offset:512
  v_mfma_f32_16x16x32_bf16 v[52:55], v[28:31], v[244:247], v[52:55]
  v_add_f32 v7, 1.0, v7
  v_add_f32 v8, 1.0, v8
  ds_read_b64_tr_b16 v[20:21], v72 offset:4096
  ds_read_b64_tr_b16 v[22:23], v72 offset:4608
  v_mfma_f32_16x16x32_bf16 v[48:51], v[32:35], v[176:179], v[48:51]
  v_rcp_f32 v7, v7
  ds_read_b64_tr_b16 v[24:25], v72 offset:8192
  ds_read_b64_tr_b16 v[26:27], v72 offset:8704
  v_mfma_f32_16x16x32_bf16 v[52:55], v[32:35], v[248:251], v[52:55]
  v_rcp_f32 v8, v8
  ds_read_b64_tr_b16 v[28:29], v72 offset:12288
  v_mfma_f32_16x16x32_bf16 v[48:51], v[36:39], v[180:183], v[48:51]
  v_mul_f32 v7, v7, v46
  v_mul_f32 v8, v8, v47
  ds_read_b64_tr_b16 v[30:31], v72 offset:12800
  v_mfma_f32_16x16x32_bf16 v[52:55], v[36:39], v[252:255], v[52:55]
  v_cvt_pk_bf16_f32 v66, v3, v4
  v_cvt_pk_bf16_f32 v67, v7, v8
  ds_read_b64_tr_b16 v[32:33], v72 offset:16384
  s_waitcnt lgkmcnt(5)
  v_mfma_f32_16x16x32_bf16 v[40:43], v[16:19], v[112:115], v[76:79]
  s_add_u32 m0, s88, 15744
  ds_read_b64_tr_b16 v[34:35], v72 offset:16896
  buffer_load_dwordx4 v12, s[12:15], s55 offen offset:640 lds
  v_mfma_f32_16x16x32_bf16 v[44:47], v[16:19], v[184:187], v[76:79]
  ds_read_b64_tr_b16 v[36:37], v72 offset:20480
  v_mfma_f32_16x16x32_bf16 v[40:43], v[20:23], v[116:119], v[40:43]
  s_add_u32 m0, s88, 23936
  v_fma_f32 v3, v48, v48, s86
  v_fma_f32 v4, v49, v49, s86
  ds_read_b64_tr_b16 v[38:39], v72 offset:20992
  buffer_load_dwordx4 v12, s[12:15], s56 offen offset:640 lds
  v_mfma_f32_16x16x32_bf16 v[44:47], v[20:23], v[188:191], v[44:47]
  v_mul_f32 v3, -v48, v3
  v_mul_f32 v4, -v49, v4
  ds_read_b64_tr_b16 v[16:17], v72 offset:24576
  s_waitcnt lgkmcnt(5)
  v_mfma_f32_16x16x32_bf16 v[40:43], v[24:27], v[120:123], v[40:43]
  s_add_u32 m0, s88, 32128
  v_exp_f32 v3, v3
  ds_read_b64_tr_b16 v[18:19], v72 offset:25088
  buffer_load_dwordx4 v12, s[12:15], s57 offen offset:640 lds
  v_mfma_f32_16x16x32_bf16 v[44:47], v[24:27], v[192:195], v[44:47]
  v_exp_f32 v4, v4
  ds_read_b64_tr_b16 v[20:21], v72 offset:28672
  v_mfma_f32_16x16x32_bf16 v[40:43], v[28:31], v[124:127], v[40:43]
  v_add_f32 v3, 1.0, v3
  v_add_f32 v4, 1.0, v4
  ds_read_b64_tr_b16 v[22:23], v72 offset:29184
  v_mfma_f32_16x16x32_bf16 v[44:47], v[28:31], v[196:199], v[44:47]
  s_add_u32 m0, s88, 40320
  v_rcp_f32 v3, v3
  ds_read_b64_tr_b16 v[24:25], v72 offset:32768
  buffer_load_dwordx4 v12, s[12:15], s58 offen offset:640 lds
  s_waitcnt lgkmcnt(5)
  v_mfma_f32_16x16x32_bf16 v[40:43], v[32:35], v[128:131], v[40:43]
  v_rcp_f32 v4, v4
  ds_read_b64_tr_b16 v[26:27], v72 offset:33280
  v_mfma_f32_16x16x32_bf16 v[44:47], v[32:35], v[200:203], v[44:47]
  s_add_u32 m0, s88, 48512
  v_mul_f32 v3, v3, v48
  v_mul_f32 v4, v4, v49
  s_cbranch_vccnz L_d21
  buffer_load_dwordx4 v12, s[12:15], s59 offen offset:640 lds
L_d21:
  v_mfma_f32_16x16x32_bf16 v[40:43], v[36:39], v[132:135], v[40:43]
  v_fma_f32 v7, v50, v50, s86
  v_fma_f32 v8, v51, v51, s86
  v_mfma_f32_16x16x32_bf16 v[44:47], v[36:39], v[204:207], v[44:47]
  v_mul_f32 v7, -v50, v7
  v_mul_f32 v8, -v51, v8
  s_waitcnt lgkmcnt(0)
  s_waitcnt vmcnt(8)
  s_barrier
  v_add_u32 v72, 90112, v73
  v_mfma_f32_16x16x32_bf16 v[40:43], v[16:19], v[136:139], v[40:43]
  v_exp_f32 v7, v7
  ds_read_b64_tr_b16 v[28:29], v72 offset:0
  ds_read_b64_tr_b16 v[30:31], v72 offset:512
  v_mfma_f32_16x16x32_bf16 v[44:47], v[16:19], v[208:211], v[44:47]
  v_exp_f32 v8, v8
  ds_read_b64_tr_b16 v[32:33], v72 offset:4096
  ds_read_b64_tr_b16 v[34:35], v72 offset:4608
  v_mfma_f32_16x16x32_bf16 v[40:43], v[20:23], v[140:143], v[40:43]
  v_add_f32 v7, 1.0, v7
  v_add_f32 v8, 1.0, v8
  ds_read_b64_tr_b16 v[36:37], v72 offset:8192
  ds_read_b64_tr_b16 v[38:39], v72 offset:8704
  v_mfma_f32_16x16x32_bf16 v[44:47], v[20:23], v[212:215], v[44:47]
  v_rcp_f32 v7, v7
  ds_read_b64_tr_b16 v[16:17], v72 offset:12288
  s_waitcnt lgkmcnt(5)
  v_mfma_f32_16x16x32_bf16 v[40:43], v[24:27], v[144:147], v[40:43]
  v_rcp_f32 v8, v8
  ds_read_b64_tr_b16 v[18:19], v72 offset:12800
  v_mfma_f32_16x16x32_bf16 v[44:47], v[24:27], v[216:219], v[44:47]
  v_mul_f32 v7, v7, v50
  v_mul_f32 v8, v8, v51
  ds_read_b64_tr_b16 v[20:21], v72 offset:16384
  v_mfma_f32_16x16x32_bf16 v[40:43], v[28:31], v[148:151], v[40:43]
  s_add_u32 m0, s88, 52480
  v_cvt_pk_bf16_f32 v68, v3, v4
  v_cvt_pk_bf16_f32 v69, v7, v8
  ds_read_b64_tr_b16 v[22:23], v72 offset:16896
  buffer_load_dwordx4 v12, s[12:15], s50 offen offset:768 lds
  v_mfma_f32_16x16x32_bf16 v[44:47], v[28:31], v[220:223], v[44:47]
  v_fma_f32 v3, v52, v52, s86
  v_fma_f32 v4, v53, v53, s86
  ds_read_b64_tr_b16 v[24:25], v72 offset:20480
  s_waitcnt lgkmcnt(5)
  v_mfma_f32_16x16x32_bf16 v[40:43], v[32:35], v[152:155], v[40:43]
  s_add_u32 m0, s88, 60672
  v_mul_f32 v3, -v52, v3
  v_mul_f32 v4, -v53, v4
  ds_read_b64_tr_b16 v[26:27], v72 offset:20992
  buffer_load_dwordx4 v12, s[12:15], s51 offen offset:768 lds
  v_mfma_f32_16x16x32_bf16 v[44:47], v[32:35], v[224:227], v[44:47]
  v_exp_f32 v3, v3
  ds_read_b64_tr_b16 v[28:29], v72 offset:24576
  v_mfma_f32_16x16x32_bf16 v[40:43], v[36:39], v[156:159], v[40:43]
  s_add_u32 m0, s88, 68864
  v_exp_f32 v4, v4
  ds_read_b64_tr_b16 v[30:31], v72 offset:25088
  buffer_load_dwordx4 v12, s[12:15], s52 offen offset:768 lds
  v_mfma_f32_16x16x32_bf16 v[44:47], v[36:39], v[228:231], v[44:47]
  v_add_f32 v3, 1.0, v3
  v_add_f32 v4, 1.0, v4
  ds_read_b64_tr_b16 v[32:33], v72 offset:28672
  s_waitcnt lgkmcnt(5)
  v_mfma_f32_16x16x32_bf16 v[40:43], v[16:19], v[160:163], v[40:43]
  v_rcp_f32 v3, v3
  ds_read_b128 v[80:83], v75 offset:1280
  ds_read_b64_tr_b16 v[34:35], v72 offset:29184
  v_mfma_f32_16x16x32_bf16 v[44:47], v[16:19], v[232:235], v[44:47]
  s_add_u32 m0, s88, 77056
  v_rcp_f32 v4, v4
  ds_read_b64_tr_b16 v[36:37], v72 offset:32768
  buffer_load_dwordx4 v12, s[12:15], s53 offen offset:768 lds
  v_mfma_f32_16x16x32_bf16 v[40:43], v[20:23], v[164:167], v[40:43]
  v_mul_f32 v3, v3, v52
  v_mul_f32 v4, v4, v53
  ds_read_b64_tr_b16 v[38:39], v72 offset:33280
  v_mfma_f32_16x16x32_bf16 v[44:47], v[20:23], v[236:239], v[44:47]
  s_add_u32 m0, s88, 85248
  v_fma_f32 v7, v54, v54, s86
  v_fma_f32 v8, v55, v55, s86
  s_cbranch_vccnz L_d22
  buffer_load_dwordx4 v12, s[12:15], s54 offen offset:768 lds
L_d22:
  s_waitcnt lgkmcnt(5)
  v_mfma_f32_16x16x32_bf16 v[40:43], v[24:27], v[168:171], v[40:43]
  v_mul_f32 v7, -v54, v7
  v_mul_f32 v8, -v55, v8
  v_mfma_f32_16x16x32_bf16 v[44:47], v[24:27], v[240:243], v[44:47]
  v_exp_f32 v7, v7
  s_waitcnt lgkmcnt(0)
  s_waitcnt vmcnt(8)
  s_barrier
  v_add_u32 v72, 126976, v73
  v_mfma_f32_16x16x32_bf16 v[40:43], v[28:31], v[172:175], v[40:43]
  v_exp_f32 v8, v8
  ds_read_b64_tr_b16 v[16:17], v72 offset:0
  ds_read_b64_tr_b16 v[18:19], v72 offset:512
  v_mfma_f32_16x16x32_bf16 v[44:47], v[28:31], v[244:247], v[44:47]
  v_add_f32 v7, 1.0, v7
  v_add_f32 v8, 1.0, v8
  ds_read_b64_tr_b16 v[20:21], v72 offset:4096
  ds_read_b64_tr_b16 v[22:23], v72 offset:4608
  v_mfma_f32_16x16x32_bf16 v[40:43], v[32:35], v[176:179], v[40:43]
  v_rcp_f32 v7, v7
  ds_read_b64_tr_b16 v[24:25], v72 offset:8192
  ds_read_b64_tr_b16 v[26:27], v72 offset:8704
  v_mfma_f32_16x16x32_bf16 v[44:47], v[32:35], v[248:251], v[44:47]
  v_rcp_f32 v8, v8
  ds_read_b64_tr_b16 v[28:29], v72 offset:12288
  v_mfma_f32_16x16x32_bf16 v[40:43], v[36:39], v[180:183], v[40:43]
  v_mul_f32 v7, v7, v54
  v_mul_f32 v8, v8, v55
  ds_read_b64_tr_b16 v[30:31], v72 offset:12800
  v_mfma_f32_16x16x32_bf16 v[44:47], v[36:39], v[252:255], v[44:47]
  v_cvt_pk_bf16_f32 v70, v3, v4
  v_cvt_pk_bf16_f32 v71, v7, v8
  ds_read_b64_tr_b16 v[32:33], v72 offset:16384
  s_waitcnt lgkmcnt(5)
  v_mfma_f32_16x16x32_bf16 v[48:51], v[16:19], v[112:115], v[80:83]
  s_add_u32 m0, s88, 89344
  ds_read_b64_tr_b16 v[34:35], v72 offset:16896
  buffer_load_dwordx4 v12, s[12:15], s55 offen offset:768 lds
  v_mfma_f32_16x16x32_bf16 v[52:55], v[16:19], v[184:187], v[80:83]
  ds_read_b64_tr_b16 v[36:37], v72 offset:20480
  v_mfma_f32_16x16x32_bf16 v[48:51], v[20:23], v[116:119], v[48:51]
  s_add_u32 m0, s88, 97536
  v_fma_f32 v3, v40, v40, s86
  v_fma_f32 v4, v41, v41, s86
  ds_read_b64_tr_b16 v[38:39], v72 offset:20992
  buffer_load_dwordx4 v12, s[12:15], s56 offen offset:768 lds
  v_mfma_f32_16x16x32_bf16 v[52:55], v[20:23], v[188:191], v[52:55]
  v_mul_f32 v3, -v40, v3
  v_mul_f32 v4, -v41, v4
  ds_read_b64_tr_b16 v[16:17], v72 offset:24576
  s_waitcnt lgkmcnt(5)
  v_mfma_f32_16x16x32_bf16 v[48:51], v[24:27], v[120:123], v[48:51]
  s_add_u32 m0, s88, 105728
  v_exp_f32 v3, v3
  ds_read_b64_tr_b16 v[18:19], v72 offset:25088
  buffer_load_dwordx4 v12, s[12:15], s57 offen offset:768 lds
  v_mfma_f32_16x16x32_bf16 v[52:55], v[24:27], v[192:195], v[52:55]
  v_exp_f32 v4, v4
  ds_read_b64_tr_b16 v[20:21], v72 offset:28672
  v_mfma_f32_16x16x32_bf16 v[48:51], v[28:31], v[124:127], v[48:51]
  v_add_f32 v3, 1.0, v3
  v_add_f32 v4, 1.0, v4
  ds_read_b64_tr_b16 v[22:23], v72 offset:29184
  v_mfma_f32_16x16x32_bf16 v[52:55], v[28:31], v[196:199], v[52:55]
  s_add_u32 m0, s88, 113920
  v_rcp_f32 v3, v3
  ds_read_b64_tr_b16 v[24:25], v72 offset:32768
  buffer_load_dwordx4 v12, s[12:15], s58 offen offset:768 lds
  s_waitcnt lgkmcnt(5)
  v_mfma_f32_16x16x32_bf16 v[48:51], v[32:35], v[128:131], v[48:51]
  v_rcp_f32 v4, v4
  ds_read_b64_tr_b16 v[26:27], v72 offset:33280
  v_mfma_f32_16x16x32_bf16 v[52:55], v[32:35], v[200:203], v[52:55]
  s_add_u32 m0, s88, 122112
  v_mul_f32 v3, v3, v40
  v_mul_f32 v4, v4, v41
  s_cbranch_vccnz L_d23
  buffer_load_dwordx4 v12, s[12:15], s59 offen offset:768 lds
L_d23:
  v_mfma_f32_16x16x32_bf16 v[48:51], v[36:39], v[132:135], v[48:51]
  v_fma_f32 v7, v42, v42, s86
  v_fma_f32 v8, v43, v43, s86
  v_mfma_f32_16x16x32_bf16 v[52:55], v[36:39], v[204:207], v[52:55]
  v_mul_f32 v7, -v42, v7
  v_mul_f32 v8, -v43, v8
  s_waitcnt lgkmcnt(0)
  s_waitcnt vmcnt(8)
  s_barrier
  v_add_u32 v72, 16384, v73
  v_mfma_f32_16x16x32_bf16 v[48:51], v[16:19], v[136:139], v[48:51]
  v_exp_f32 v7, v7
  ds_read_b64_tr_b16 v[28:29], v72 offset:0
  ds_read_b64_tr_b16 v[30:31], v72 offset:512
  v_mfma_f32_16x16x32_bf16 v[52:55], v[16:19], v[208:211], v[52:55]
  v_exp_f32 v8, v8
  ds_read_b64_tr_b16 v[32:33], v72 offset:4096
  ds_read_b64_tr_b16 v[34:35], v72 offset:4608
  v_mfma_f32_16x16x32_bf16 v[48:51], v[20:23], v[140:143], v[48:51]
  v_add_f32 v7, 1.0, v7
  v_add_f32 v8, 1.0, v8
  ds_read_b64_tr_b16 v[36:37], v72 offset:8192
  ds_read_b64_tr_b16 v[38:39], v72 offset:8704
  v_mfma_f32_16x16x32_bf16 v[52:55], v[20:23], v[212:215], v[52:55]
  v_rcp_f32 v7, v7
  ds_read_b64_tr_b16 v[16:17], v72 offset:12288
  s_waitcnt lgkmcnt(5)
  v_mfma_f32_16x16x32_bf16 v[48:51], v[24:27], v[144:147], v[48:51]
  v_rcp_f32 v8, v8
  ds_read_b64_tr_b16 v[18:19], v72 offset:12800
  v_mfma_f32_16x16x32_bf16 v[52:55], v[24:27], v[216:219], v[52:55]
  v_mul_f32 v7, v7, v42
  v_mul_f32 v8, v8, v43
  ds_read_b64_tr_b16 v[20:21], v72 offset:16384
  v_mfma_f32_16x16x32_bf16 v[48:51], v[28:31], v[148:151], v[48:51]
  s_add_u32 m0, s88, 126080
  v_cvt_pk_bf16_f32 v84, v3, v4
  v_cvt_pk_bf16_f32 v85, v7, v8
  ds_read_b64_tr_b16 v[22:23], v72 offset:16896
  buffer_load_dwordx4 v12, s[12:15], s50 offen offset:896 lds
  v_mfma_f32_16x16x32_bf16 v[52:55], v[28:31], v[220:223], v[52:55]
  v_fma_f32 v3, v44, v44, s86
  v_fma_f32 v4, v45, v45, s86
  ds_read_b64_tr_b16 v[24:25], v72 offset:20480
  s_waitcnt lgkmcnt(5)
  v_mfma_f32_16x16x32_bf16 v[48:51], v[32:35], v[152:155], v[48:51]
  s_add_u32 m0, s88, 134272
  v_mul_f32 v3, -v44, v3
  v_mul_f32 v4, -v45, v4
  ds_read_b64_tr_b16 v[26:27], v72 offset:20992
  buffer_load_dwordx4 v12, s[12:15], s51 offen offset:896 lds
  v_mfma_f32_16x16x32_bf16 v[52:55], v[32:35], v[224:227], v[52:55]
  v_exp_f32 v3, v3
  ds_read_b64_tr_b16 v[28:29], v72 offset:24576
  v_mfma_f32_16x16x32_bf16 v[48:51], v[36:39], v[156:159], v[48:51]
  s_add_u32 m0, s88, 142464
  v_exp_f32 v4, v4
  ds_read_b64_tr_b16 v[30:31], v72 offset:25088
  buffer_load_dwordx4 v12, s[12:15], s52 offen offset:896 lds
  v_mfma_f32_16x16x32_bf16 v[52:55], v[36:39], v[228:231], v[52:55]
  v_add_f32 v3, 1.0, v3
  v_add_f32 v4, 1.0, v4
  ds_read_b64_tr_b16 v[32:33], v72 offset:28672
  s_waitcnt lgkmcnt(5)
  v_mfma_f32_16x16x32_bf16 v[48:51], v[16:19], v[160:163], v[48:51]
  v_rcp_f32 v3, v3
  ds_read_b128 v[76:79], v75 offset:1536
  ds_read_b64_tr_b16 v[34:35], v72 offset:29184
  v_mfma_f32_16x16x32_bf16 v[52:55], v[16:19], v[232:235], v[52:55]
  s_add_u32 m0, s88, 150656
  v_rcp_f32 v4, v4
  ds_read_b64_tr_b16 v[36:37], v72 offset:32768
  buffer_load_dwordx4 v12, s[12:15], s53 offen offset:896 lds
  v_mfma_f32_16x16x32_bf16 v[48:51], v[20:23], v[164:167], v[48:51]
  v_mul_f32 v3, v3, v44
  v_mul_f32 v4, v4, v45
  ds_read_b64_tr_b16 v[38:39], v72 offset:33280
  v_mfma_f32_16x16x32_bf16 v[52:55], v[20:23], v[236:239], v[52:55]
  s_add_u32 m0, s88, 158848
  v_fma_f32 v7, v46, v46, s86
  v_fma_f32 v8, v47, v47, s86
  s_cbranch_vccnz L_d24
  buffer_load_dwordx4 v12, s[12:15], s54 offen offset:896 lds
L_d24:
  s_waitcnt lgkmcnt(5)
  v_mfma_f32_16x16x32_bf16 v[48:51], v[24:27], v[168:171], v[48:51]
  v_mul_f32 v7, -v46, v7
  v_mul_f32 v8, -v47, v8
  v_mfma_f32_16x16x32_bf16 v[52:55], v[24:27], v[240:243], v[52:55]
  v_exp_f32 v7, v7
  s_waitcnt lgkmcnt(0)
  s_waitcnt vmcnt(8)
  s_barrier
  v_add_u32 v72, 53248, v73
  v_mfma_f32_16x16x32_bf16 v[48:51], v[28:31], v[172:175], v[48:51]
  v_exp_f32 v8, v8
  ds_read_b64_tr_b16 v[16:17], v72 offset:0
  ds_read_b64_tr_b16 v[18:19], v72 offset:512
  v_mfma_f32_16x16x32_bf16 v[52:55], v[28:31], v[244:247], v[52:55]
  v_add_f32 v7, 1.0, v7
  v_add_f32 v8, 1.0, v8
  ds_read_b64_tr_b16 v[20:21], v72 offset:4096
  ds_read_b64_tr_b16 v[22:23], v72 offset:4608
  v_mfma_f32_16x16x32_bf16 v[48:51], v[32:35], v[176:179], v[48:51]
  v_rcp_f32 v7, v7
  ds_read_b64_tr_b16 v[24:25], v72 offset:8192
  ds_read_b64_tr_b16 v[26:27], v72 offset:8704
  v_mfma_f32_16x16x32_bf16 v[52:55], v[32:35], v[248:251], v[52:55]
  v_rcp_f32 v8, v8
  ds_read_b64_tr_b16 v[28:29], v72 offset:12288
  v_mfma_f32_16x16x32_bf16 v[48:51], v[36:39], v[180:183], v[48:51]
  v_mul_f32 v7, v7, v46
  v_mul_f32 v8, v8, v47
  ds_read_b64_tr_b16 v[30:31], v72 offset:12800
  v_mfma_f32_16x16x32_bf16 v[52:55], v[36:39], v[252:255], v[52:55]
  v_cvt_pk_bf16_f32 v86, v3, v4
  v_cvt_pk_bf16_f32 v87, v7, v8
  ds_read_b64_tr_b16 v[32:33], v72 offset:16384
  s_waitcnt lgkmcnt(5)
  v_mfma_f32_16x16x32_bf16 v[40:43], v[16:19], v[112:115], v[76:79]
  s_add_u32 m0, s88, 15488
  ds_read_b64_tr_b16 v[34:35], v72 offset:16896
  buffer_load_dwordx4 v12, s[12:15], s55 offen offset:896 lds
  v_mfma_f32_16x16x32_bf16 v[44:47], v[16:19], v[184:187], v[76:79]
  ds_read_b64_tr_b16 v[36:37], v72 offset:20480
  v_mfma_f32_16x16x32_bf16 v[40:43], v[20:23], v[116:119], v[40:43]
  s_add_u32 m0, s88, 23680
  v_fma_f32 v3, v48, v48, s86
  v_fma_f32 v4, v49, v49, s86
  ds_read_b64_tr_b16 v[38:39], v72 offset:20992
  buffer_load_dwordx4 v12, s[12:15], s56 offen offset:896 lds
  v_mfma_f32_16x16x32_bf16 v[44:47], v[20:23], v[188:191], v[44:47]
  v_mul_f32 v3, -v48, v3
  v_mul_f32 v4, -v49, v4
  ds_read_b64_tr_b16 v[16:17], v72 offset:24576
  s_waitcnt lgkmcnt(5)
  v_mfma_f32_16x16x32_bf16 v[40:43], v[24:27], v[120:123], v[40:43]
  s_add_u32 m0, s88, 31872
  v_exp_f32 v3, v3
  ds_read_b64_tr_b16 v[18:19], v72 offset:25088
  buffer_load_dwordx4 v12, s[12:15], s57 offen offset:896 lds
  v_mfma_f32_16x16x32_bf16 v[44:47], v[24:27], v[192:195], v[44:47]
  v_exp_f32 v4, v4
  ds_read_b64_tr_b16 v[20:21], v72 offset:28672
  v_mfma_f32_16x16x32_bf16 v[40:43], v[28:31], v[124:127], v[40:43]
  v_add_f32 v3, 1.0, v3
  v_add_f32 v4, 1.0, v4
  ds_read_b64_tr_b16 v[22:23], v72 offset:29184
  v_mfma_f32_16x16x32_bf16 v[44:47], v[28:31], v[196:199], v[44:47]
  s_add_u32 m0, s88, 40064
  v_rcp_f32 v3, v3
  ds_read_b64_tr_b16 v[24:25], v72 offset:32768
  buffer_load_dwordx4 v12, s[12:15], s58 offen offset:896 lds
  s_waitcnt lgkmcnt(5)
  v_mfma_f32_16x16x32_bf16 v[40:43], v[32:35], v[128:131], v[40:43]
  v_rcp_f32 v4, v4
  ds_read_b64_tr_b16 v[26:27], v72 offset:33280
  v_mfma_f32_16x16x32_bf16 v[44:47], v[32:35], v[200:203], v[44:47]
  s_add_u32 m0, s88, 48256
  v_mul_f32 v3, v3, v48
  v_mul_f32 v4, v4, v49
  s_cbranch_vccnz L_d25
  buffer_load_dwordx4 v12, s[12:15], s59 offen offset:896 lds
L_d25:
  v_mfma_f32_16x16x32_bf16 v[40:43], v[36:39], v[132:135], v[40:43]
  v_fma_f32 v7, v50, v50, s86
  v_fma_f32 v8, v51, v51, s86
  v_mfma_f32_16x16x32_bf16 v[44:47], v[36:39], v[204:207], v[44:47]
  v_mul_f32 v7, -v50, v7
  v_mul_f32 v8, -v51, v8
  s_waitcnt lgkmcnt(0)
  s_waitcnt vmcnt(8)
  s_barrier
  v_add_u32 v72, 90112, v73
  v_mfma_f32_16x16x32_bf16 v[40:43], v[16:19], v[136:139], v[40:43]
  v_exp_f32 v7, v7
  ds_read_b64_tr_b16 v[28:29], v72 offset:0
  ds_read_b64_tr_b16 v[30:31], v72 offset:512
  v_mfma_f32_16x16x32_bf16 v[44:47], v[16:19], v[208:211], v[44:47]
  v_exp_f32 v8, v8
  ds_read_b64_tr_b16 v[32:33], v72 offset:4096
  ds_read_b64_tr_b16 v[34:35], v72 offset:4608
  v_mfma_f32_16x16x32_bf16 v[40:43], v[20:23], v[140:143], v[40:43]
  v_add_f32 v7, 1.0, v7
  v_add_f32 v8, 1.0, v8
  ds_read_b64_tr_b16 v[36:37], v72 offset:8192
  ds_read_b64_tr_b16 v[38:39], v72 offset:8704
  v_mfma_f32_16x16x32_bf16 v[44:47], v[20:23], v[212:215], v[44:47]
  v_rcp_f32 v7, v7
  ds_read_b64_tr_b16 v[16:17], v72 offset:12288
  s_waitcnt lgkmcnt(5)
  v_mfma_f32_16x16x32_bf16 v[40:43], v[24:27], v[144:147], v[40:43]
  v_rcp_f32 v8, v8
  ds_read_b64_tr_b16 v[18:19], v72 offset:12800
  v_mfma_f32_16x16x32_bf16 v[44:47], v[24:27], v[216:219], v[44:47]
  v_mul_f32 v7, v7, v50
  v_mul_f32 v8, v8, v51
  ds_read_b64_tr_b16 v[20:21], v72 offset:16384
  v_mfma_f32_16x16x32_bf16 v[40:43], v[28:31], v[148:151], v[40:43]
  s_add_u32 m0, s88, 52224
  v_cvt_pk_bf16_f32 v88, v3, v4
  v_cvt_pk_bf16_f32 v89, v7, v8
  ds_read_b64_tr_b16 v[22:23], v72 offset:16896
  buffer_load_dwordx4 v12, s[12:15], s50 offen offset:1024 lds
  v_mfma_f32_16x16x32_bf16 v[44:47], v[28:31], v[220:223], v[44:47]
  v_fma_f32 v3, v52, v52, s86
  v_fma_f32 v4, v53, v53, s86
  ds_read_b64_tr_b16 v[24:25], v72 offset:20480
  s_waitcnt lgkmcnt(5)
  v_mfma_f32_16x16x32_bf16 v[40:43], v[32:35], v[152:155], v[40:43]
  s_add_u32 m0, s88, 60416
  v_mul_f32 v3, -v52, v3
  v_mul_f32 v4, -v53, v4
  ds_read_b64_tr_b16 v[26:27], v72 offset:20992
  buffer_load_dwordx4 v12, s[12:15], s51 offen offset:1024 lds
  v_mfma_f32_16x16x32_bf16 v[44:47], v[32:35], v[224:227], v[44:47]
  v_exp_f32 v3, v3
  ds_read_b64_tr_b16 v[28:29], v72 offset:24576
  v_mfma_f32_16x16x32_bf16 v[40:43], v[36:39], v[156:159], v[40:43]
  s_add_u32 m0, s88, 68608
  v_exp_f32 v4, v4
  ds_read_b64_tr_b16 v[30:31], v72 offset:25088
  buffer_load_dwordx4 v12, s[12:15], s52 offen offset:1024 lds
  v_mfma_f32_16x16x32_bf16 v[44:47], v[36:39], v[228:231], v[44:47]
  v_add_f32 v3, 1.0, v3
  v_add_f32 v4, 1.0, v4
  ds_read_b64_tr_b16 v[32:33], v72 offset:28672
  s_waitcnt lgkmcnt(5)
  v_mfma_f32_16x16x32_bf16 v[40:43], v[16:19], v[160:163], v[40:43]
  v_rcp_f32 v3, v3
  ds_read_b128 v[80:83], v75 offset:1792
  ds_read_b64_tr_b16 v[34:35], v72 offset:29184
  v_mfma_f32_16x16x32_bf16 v[44:47], v[16:19], v[232:235], v[44:47]
  s_add_u32 m0, s88, 76800
  v_rcp_f32 v4, v4
  ds_read_b64_tr_b16 v[36:37], v72 offset:32768
  buffer_load_dwordx4 v12, s[12:15], s53 offen offset:1024 lds
  v_mfma_f32_16x16x32_bf16 v[40:43], v[20:23], v[164:167], v[40:43]
  v_mul_f32 v3, v3, v52
  v_mul_f32 v4, v4, v53
  ds_read_b64_tr_b16 v[38:39], v72 offset:33280
  v_mfma_f32_16x16x32_bf16 v[44:47], v[20:23], v[236:239], v[44:47]
  s_add_u32 m0, s88, 84992
  v_fma_f32 v7, v54, v54, s86
  v_fma_f32 v8, v55, v55, s86
  s_cbranch_vccnz L_d26
  buffer_load_dwordx4 v12, s[12:15], s54 offen offset:1024 lds
L_d26:
  s_waitcnt lgkmcnt(5)
  v_mfma_f32_16x16x32_bf16 v[40:43], v[24:27], v[168:171], v[40:43]
  v_mul_f32 v7, -v54, v7
  v_mul_f32 v8, -v55, v8
  v_mfma_f32_16x16x32_bf16 v[44:47], v[24:27], v[240:243], v[44:47]
  v_exp_f32 v7, v7
  s_waitcnt lgkmcnt(0)
  s_waitcnt vmcnt(8)
  s_barrier
  v_add_u32 v72, 126976, v73
  v_mfma_f32_16x16x32_bf16 v[40:43], v[28:31], v[172:175], v[40:43]
  v_exp_f32 v8, v8
  ds_read_b64_tr_b16 v[16:17], v72 offset:0
  ds_read_b64_tr_b16 v[18:19], v72 offset:512
  v_mfma_f32_16x16x32_bf16 v[44:47], v[28:31], v[244:247], v[44:47]
  v_add_f32 v7, 1.0, v7
  v_add_f32 v8, 1.0, v8
  ds_read_b64_tr_b16 v[20:21], v72 offset:4096
  ds_read_b64_tr_b16 v[22:23], v72 offset:4608
  v_mfma_f32_16x16x32_bf16 v[40:43], v[32:35], v[176:179], v[40:43]
  v_rcp_f32 v7, v7
  ds_read_b64_tr_b16 v[24:25], v72 offset:8192
  ds_read_b64_tr_b16 v[26:27], v72 offset:8704
  v_mfma_f32_16x16x32_bf16 v[44:47], v[32:35], v[248:251], v[44:47]
  v_rcp_f32 v8, v8
  ds_read_b64_tr_b16 v[28:29], v72 offset:12288
  v_mfma_f32_16x16x32_bf16 v[40:43], v[36:39], v[180:183], v[40:43]
  v_mul_f32 v7, v7, v54
  v_mul_f32 v8, v8, v55
  ds_read_b64_tr_b16 v[30:31], v72 offset:12800
  v_mfma_f32_16x16x32_bf16 v[44:47], v[36:39], v[252:255], v[44:47]
  v_cvt_pk_bf16_f32 v90, v3, v4
  v_cvt_pk_bf16_f32 v91, v7, v8
  ds_read_b64_tr_b16 v[32:33], v72 offset:16384
  s_waitcnt lgkmcnt(5)
  v_mfma_f32_16x16x32_bf16 v[48:51], v[16:19], v[112:115], v[80:83]
  s_add_u32 m0, s88, 89088
  ds_read_b64_tr_b16 v[34:35], v72 offset:16896
  buffer_load_dwordx4 v12, s[12:15], s55 offen offset:1024 lds
  v_mfma_f32_16x16x32_bf16 v[52:55], v[16:19], v[184:187], v[80:83]
  ds_read_b64_tr_b16 v[36:37], v72 offset:20480
  v_mfma_f32_16x16x32_bf16 v[48:51], v[20:23], v[116:119], v[48:51]
  s_add_u32 m0, s88, 97280
  v_fma_f32 v3, v40, v40, s86
  v_fma_f32 v4, v41, v41, s86
  ds_read_b64_tr_b16 v[38:39], v72 offset:20992
  buffer_load_dwordx4 v12, s[12:15], s56 offen offset:1024 lds
  v_mfma_f32_16x16x32_bf16 v[52:55], v[20:23], v[188:191], v[52:55]
  v_mul_f32 v3, -v40, v3
  v_mul_f32 v4, -v41, v4
  ds_read_b64_tr_b16 v[16:17], v72 offset:24576
  s_waitcnt lgkmcnt(5)
  v_mfma_f32_16x16x32_bf16 v[48:51], v[24:27], v[120:123], v[48:51]
  s_add_u32 m0, s88, 105472
  v_exp_f32 v3, v3
  ds_read_b64_tr_b16 v[18:19], v72 offset:25088
  buffer_load_dwordx4 v12, s[12:15], s57 offen offset:1024 lds
  v_mfma_f32_16x16x32_bf16 v[52:55], v[24:27], v[192:195], v[52:55]
  v_exp_f32 v4, v4
  ds_read_b64_tr_b16 v[20:21], v72 offset:28672
  v_mfma_f32_16x16x32_bf16 v[48:51], v[28:31], v[124:127], v[48:51]
  v_add_f32 v3, 1.0, v3
  v_add_f32 v4, 1.0, v4
  ds_read_b64_tr_b16 v[22:23], v72 offset:29184
  v_mfma_f32_16x16x32_bf16 v[52:55], v[28:31], v[196:199], v[52:55]
  s_add_u32 m0, s88, 113664
  v_rcp_f32 v3, v3
  ds_read_b64_tr_b16 v[24:25], v72 offset:32768
  buffer_load_dwordx4 v12, s[12:15], s58 offen offset:1024 lds
  s_waitcnt lgkmcnt(5)
  v_mfma_f32_16x16x32_bf16 v[48:51], v[32:35], v[128:131], v[48:51]
  v_rcp_f32 v4, v4
  ds_read_b64_tr_b16 v[26:27], v72 offset:33280
  v_mfma_f32_16x16x32_bf16 v[52:55], v[32:35], v[200:203], v[52:55]
  s_add_u32 m0, s88, 121856
  v_mul_f32 v3, v3, v40
  v_mul_f32 v4, v4, v41
  s_cbranch_vccnz L_d27
  buffer_load_dwordx4 v12, s[12:15], s59 offen offset:1024 lds
L_d27:
  v_mfma_f32_16x16x32_bf16 v[48:51], v[36:39], v[132:135], v[48:51]
  v_fma_f32 v7, v42, v42, s86
  v_fma_f32 v8, v43, v43, s86
  v_mfma_f32_16x16x32_bf16 v[52:55], v[36:39], v[204:207], v[52:55]
  v_mul_f32 v7, -v42, v7
  v_mul_f32 v8, -v43, v8
  s_waitcnt lgkmcnt(0)
  s_waitcnt vmcnt(8)
  s_barrier
  v_add_u32 v72, 16384, v73
  v_and_b32 v110, 7, v0
  v_lshlrev_b32 v110, 2, v110
  s_lshl_b32 s44, s39, 5
  v_add_u32 v110, s44, v110
  global_load_dword v110, v110, s[28:29] sc0 sc1
  v_mfma_f32_16x16x32_bf16 v[48:51], v[16:19], v[136:139], v[48:51]
  v_exp_f32 v7, v7
  ds_read_b64_tr_b16 v[28:29], v72 offset:0
  ds_read_b64_tr_b16 v[30:31], v72 offset:512
  v_mfma_f32_16x16x32_bf16 v[52:55], v[16:19], v[208:211], v[52:55]
  v_exp_f32 v8, v8
  ds_read_b64_tr_b16 v[32:33], v72 offset:4096
  ds_read_b64_tr_b16 v[34:35], v72 offset:4608
  v_mfma_f32_16x16x32_bf16 v[48:51], v[20:23], v[140:143], v[48:51]
  v_add_f32 v7, 1.0, v7
  v_add_f32 v8, 1.0, v8
  ds_read_b64_tr_b16 v[36:37], v72 offset:8192
  ds_read_b64_tr_b16 v[38:39], v72 offset:8704
  v_mfma_f32_16x16x32_bf16 v[52:55], v[20:23], v[212:215], v[52:55]
  v_rcp_f32 v7, v7
  ds_read_b64_tr_b16 v[16:17], v72 offset:12288
  s_waitcnt lgkmcnt(5)
  v_mfma_f32_16x16x32_bf16 v[48:51], v[24:27], v[144:147], v[48:51]
  v_rcp_f32 v8, v8
  ds_read_b64_tr_b16 v[18:19], v72 offset:12800
  v_mfma_f32_16x16x32_bf16 v[52:55], v[24:27], v[216:219], v[52:55]
  v_mul_f32 v7, v7, v42
  v_mul_f32 v8, v8, v43
  ds_read_b64_tr_b16 v[20:21], v72 offset:16384
  v_mfma_f32_16x16x32_bf16 v[48:51], v[28:31], v[148:151], v[48:51]
  s_add_u32 m0, s88, 131072
  v_cvt_pk_bf16_f32 v92, v3, v4
  v_cvt_pk_bf16_f32 v93, v7, v8
  ds_read_b64_tr_b16 v[22:23], v72 offset:16896
  buffer_load_dwordx4 v13, s[16:19], s60 offen offset:0 lds
  v_mfma_f32_16x16x32_bf16 v[52:55], v[28:31], v[220:223], v[52:55]
  v_fma_f32 v3, v44, v44, s86
  v_fma_f32 v4, v45, v45, s86
  ds_read_b64_tr_b16 v[24:25], v72 offset:20480
  s_waitcnt lgkmcnt(5)
  v_mfma_f32_16x16x32_bf16 v[48:51], v[32:35], v[152:155], v[48:51]
  v_mul_f32 v3, -v44, v3
  v_mul_f32 v4, -v45, v4
  ds_read_b64_tr_b16 v[26:27], v72 offset:20992
  v_mfma_f32_16x16x32_bf16 v[52:55], v[32:35], v[224:227], v[52:55]
  s_add_u32 m0, s88, 139264
  v_exp_f32 v3, v3
  ds_read_b64_tr_b16 v[28:29], v72 offset:24576
  buffer_load_dwordx4 v13, s[16:19], s61 offen offset:0 lds
  v_mfma_f32_16x16x32_bf16 v[48:51], v[36:39], v[156:159], v[48:51]
  v_exp_f32 v4, v4
  ds_read_b64_tr_b16 v[30:31], v72 offset:25088
  v_mfma_f32_16x16x32_bf16 v[52:55], v[36:39], v[228:231], v[52:55]
  v_add_f32 v3, 1.0, v3
  v_add_f32 v4, 1.0, v4
  ds_read_b64_tr_b16 v[32:33], v72 offset:28672
  s_waitcnt lgkmcnt(5)
  v_mfma_f32_16x16x32_bf16 v[48:51], v[16:19], v[160:163], v[48:51]
  s_add_u32 m0, s88, 147456
  v_rcp_f32 v3, v3
  ds_read_b128 v[76:79], v75 offset:2048
  ds_read_b64_tr_b16 v[34:35], v72 offset:29184
  buffer_load_dwordx4 v13, s[16:19], s62 offen offset:0 lds
  v_mfma_f32_16x16x32_bf16 v[52:55], v[16:19], v[232:235], v[52:55]
  v_rcp_f32 v4, v4
  ds_read_b64_tr_b16 v[36:37], v72 offset:32768
  v_mfma_f32_16x16x32_bf16 v[48:51], v[20:23], v[164:167], v[48:51]
  v_mul_f32 v3, v3, v44
  v_mul_f32 v4, v4, v45
  ds_read_b64_tr_b16 v[38:39], v72 offset:33280
  v_mfma_f32_16x16x32_bf16 v[52:55], v[20:23], v[236:239], v[52:55]
  s_add_u32 m0, s88, 155648
  v_fma_f32 v7, v46, v46, s86
  v_fma_f32 v8, v47, v47, s86
  s_cbranch_vccnz L_d28
  buffer_load_dwordx4 v13, s[16:19], s63 offen offset:0 lds
L_d28:
  s_waitcnt lgkmcnt(5)
  v_mfma_f32_16x16x32_bf16 v[48:51], v[24:27], v[168:171], v[48:51]
  v_mul_f32 v7, -v46, v7
  v_mul_f32 v8, -v47, v8
  v_mfma_f32_16x16x32_bf16 v[52:55], v[24:27], v[240:243], v[52:55]
  v_exp_f32 v7, v7
  s_waitcnt lgkmcnt(0)
  s_waitcnt vmcnt(8)
  s_barrier
  v_add_u32 v72, 53248, v73
  v_mfma_f32_16x16x32_bf16 v[48:51], v[28:31], v[172:175], v[48:51]
  v_exp_f32 v8, v8
  ds_read_b64_tr_b16 v[16:17], v72 offset:0
  ds_read_b64_tr_b16 v[18:19], v72 offset:512
  v_mfma_f32_16x16x32_bf16 v[52:55], v[28:31], v[244:247], v[52:55]
  v_add_f32 v7, 1.0, v7
  v_add_f32 v8, 1.0, v8
  ds_read_b64_tr_b16 v[20:21], v72 offset:4096
  ds_read_b64_tr_b16 v[22:23], v72 offset:4608
  v_mfma_f32_16x16x32_bf16 v[48:51], v[32:35], v[176:179], v[48:51]
  v_rcp_f32 v7, v7
  ds_read_b64_tr_b16 v[24:25], v72 offset:8192
  ds_read_b64_tr_b16 v[26:27], v72 offset:8704
  v_mfma_f32_16x16x32_bf16 v[52:55], v[32:35], v[248:251], v[52:55]
  v_rcp_f32 v8, v8
  ds_read_b64_tr_b16 v[28:29], v72 offset:12288
  v_mfma_f32_16x16x32_bf16 v[48:51], v[36:39], v[180:183], v[48:51]
  v_mul_f32 v7, v7, v46
  v_mul_f32 v8, v8, v47
  ds_read_b64_tr_b16 v[30:31], v72 offset:12800
  v_mfma_f32_16x16x32_bf16 v[52:55], v[36:39], v[252:255], v[52:55]
  v_cvt_pk_bf16_f32 v94, v3, v4
  v_cvt_pk_bf16_f32 v95, v7, v8
  ds_read_b64_tr_b16 v[32:33], v72 offset:16384
  s_waitcnt lgkmcnt(5)
  v_mfma_f32_16x16x32_bf16 v[40:43], v[16:19], v[112:115], v[76:79]
  s_add_u32 m0, s88, 16384
  ds_read_b64_tr_b16 v[34:35], v72 offset:16896
  buffer_load_dwordx4 v13, s[16:19], s41 offen offset:0 lds
  v_mfma_f32_16x16x32_bf16 v[44:47], v[16:19], v[184:187], v[76:79]
  ds_read_b64_tr_b16 v[36:37], v72 offset:20480
  v_mfma_f32_16x16x32_bf16 v[40:43], v[20:23], v[116:119], v[40:43]
  v_fma_f32 v3, v48, v48, s86
  v_fma_f32 v4, v49, v49, s86
  ds_read_b64_tr_b16 v[38:39], v72 offset:20992
  v_mfma_f32_16x16x32_bf16 v[44:47], v[20:23], v[188:191], v[44:47]
  s_add_u32 m0, s88, 24576
  v_mul_f32 v3, -v48, v3
  v_mul_f32 v4, -v49, v4
  s_mul_i32 s48, s39, 17408
  s_add_u32 s48, s48, 41943040
  ds_read_b64_tr_b16 v[16:17], v72 offset:24576
  buffer_load_dwordx4 v13, s[16:19], s42 offen offset:0 lds
  s_waitcnt lgkmcnt(5)
  v_mfma_f32_16x16x32_bf16 v[40:43], v[24:27], v[120:123], v[40:43]
  v_exp_f32 v3, v3
  s_add_u32 s95, s48, s88
  s_add_u32 s49, s36, 8
  ds_read_b64_tr_b16 v[18:19], v72 offset:25088
  v_mfma_f32_16x16x32_bf16 v[44:47], v[24:27], v[192:195], v[44:47]
  v_exp_f32 v4, v4
  s_cmp_lt_u32 s36, 5
  s_cselect_b32 s49, s49, 13
  s_lshl_b32 s99, s49, 9
  s_lshl_b32 s49, s49, 10
  ds_read_b64_tr_b16 v[20:21], v72 offset:28672
  v_mfma_f32_16x16x32_bf16 v[40:43], v[28:31], v[124:127], v[40:43]
  s_add_u32 m0, s88, 32768
  v_add_f32 v3, 1.0, v3
  v_add_f32 v4, 1.0, v4
  s_add_u32 s96, s49, s48
  s_add_u32 s99, s99, 45056
  s_min_u32 s49, s36, 4
  ds_read_b64_tr_b16 v[22:23], v72 offset:29184
  buffer_load_dwordx4 v13, s[16:19], s43 offen offset:0 lds
  v_mfma_f32_16x16x32_bf16 v[44:47], v[28:31], v[196:199], v[44:47]
  v_rcp_f32 v3, v3
  s_lshl_b32 s97, s49, 6
  s_add_u32 s97, s97, s48
  s_add_u32 s97, s97, 14336
  ds_read_b64_tr_b16 v[24:25], v72 offset:32768
  s_waitcnt lgkmcnt(5)
  v_mfma_f32_16x16x32_bf16 v[40:43], v[32:35], v[128:131], v[40:43]
  v_rcp_f32 v4, v4
  s_lshl_b32 s98, s36, 9
  s_add_u32 s98, s98, 45056
  ds_read_b64_tr_b16 v[26:27], v72 offset:33280
  v_mfma_f32_16x16x32_bf16 v[44:47], v[32:35], v[200:203], v[44:47]
  s_add_u32 m0, s88, 40960
  v_mul_f32 v3, v3, v48
  v_mul_f32 v4, v4, v49
  s_lshl_b32 s3, s49, 9
  s_cbranch_vccnz L_d29
  buffer_load_dwordx4 v13, s[16:19], s65 offen offset:0 lds
L_d29:
  v_mfma_f32_16x16x32_bf16 v[40:43], v[36:39], v[132:135], v[40:43]
  v_fma_f32 v7, v50, v50, s86
  v_fma_f32 v8, v51, v51, s86
  s_cmp_lt_u32 s36, 2
  s_cselect_b32 s49, 0, 73728
  s_add_u32 s3, s3, s49
  s_add_u32 s3, s3, 52224
  v_mfma_f32_16x16x32_bf16 v[44:47], v[36:39], v[204:207], v[44:47]
  v_mul_f32 v7, -v50, v7
  v_mul_f32 v8, -v51, v8
  s_lshl_b32 s66, s38, 3
  s_lshr_b32 s66, 117702925, s66
  s_and_b32 s66, s66, 255
  s_waitcnt lgkmcnt(0)
  s_waitcnt vmcnt(7)
  s_barrier
  v_add_u32 v72, 90112, v73
  v_mfma_f32_16x16x32_bf16 v[40:43], v[16:19], v[136:139], v[40:43]
  v_exp_f32 v7, v7
  s_lshl_b32 s66, s66, 9
  s_add_u32 s66, s66, 45056
  ds_read_b64_tr_b16 v[28:29], v72 offset:0
  ds_read_b64_tr_b16 v[30:31], v72 offset:512
  v_mfma_f32_16x16x32_bf16 v[44:47], v[16:19], v[208:211], v[44:47]
  v_exp_f32 v8, v8
  s_lshl_b32 s67, s38, 3
  s_lshr_b32 s67, 151388928, s67
  s_and_b32 s67, s67, 255
  ds_read_b64_tr_b16 v[32:33], v72 offset:4096
  ds_read_b64_tr_b16 v[34:35], v72 offset:4608
  v_mfma_f32_16x16x32_bf16 v[40:43], v[20:23], v[140:143], v[40:43]
  v_add_f32 v7, 1.0, v7
  v_add_f32 v8, 1.0, v8
  s_lshl_b32 s67, s67, 9
  s_add_u32 s67, s67, 45056
  ds_read_b64_tr_b16 v[36:37], v72 offset:8192
  ds_read_b64_tr_b16 v[38:39], v72 offset:8704
  v_mfma_f32_16x16x32_bf16 v[44:47], v[20:23], v[212:215], v[44:47]
  v_rcp_f32 v7, v7
  s_lshl_b32 s68, s38, 3
  s_lshr_b32 s68, 185074946, s68
  s_and_b32 s68, s68, 255
  ds_read_b64_tr_b16 v[16:17], v72 offset:12288
  s_waitcnt lgkmcnt(5)
  v_mfma_f32_16x16x32_bf16 v[40:43], v[24:27], v[144:147], v[40:43]
  v_rcp_f32 v8, v8
  s_lshl_b32 s68, s68, 9
  s_add_u32 s68, s68, 45056
  ds_read_b64_tr_b16 v[18:19], v72 offset:12800
  v_mfma_f32_16x16x32_bf16 v[44:47], v[24:27], v[216:219], v[44:47]
  v_mul_f32 v7, v7, v50
  v_mul_f32 v8, v8, v51
  s_lshr_b32 s49, s38, 1
  s_lshl_b32 s49, s49, 12
  s_lshl_b32 s91, s37, 11
  ds_read_b64_tr_b16 v[20:21], v72 offset:16384
  v_mfma_f32_16x16x32_bf16 v[40:43], v[28:31], v[148:151], v[40:43]
  v_cvt_pk_bf16_f32 v96, v3, v4
  v_cvt_pk_bf16_f32 v97, v7, v8
  s_add_u32 s90, s49, s91
  s_and_b32 s49, s38, 1
  s_lshl_b32 s49, s49, 3
  ds_read_b64_tr_b16 v[22:23], v72 offset:16896
  v_mfma_f32_16x16x32_bf16 v[44:47], v[28:31], v[220:223], v[44:47]
  v_fma_f32 v3, v52, v52, s86
  v_fma_f32 v4, v53, v53, s86
  s_add_u32 s90, s90, s49
  s_add_u32 s90, s90, 53248
  s_add_u32 s91, s91, 53248
  ds_read_b64_tr_b16 v[24:25], v72 offset:20480
  s_waitcnt lgkmcnt(5)
  v_mfma_f32_16x16x32_bf16 v[40:43], v[32:35], v[152:155], v[40:43]
  v_mul_f32 v3, -v52, v3
  v_mul_f32 v4, -v53, v4
  s_mul_i32 s92, s37, 5120
  ds_read_b64_tr_b16 v[26:27], v72 offset:20992
  v_mfma_f32_16x16x32_bf16 v[44:47], v[32:35], v[224:227], v[44:47]
  v_exp_f32 v3, v3
  ds_read_b64_tr_b16 v[28:29], v72 offset:24576
  v_mfma_f32_16x16x32_bf16 v[40:43], v[36:39], v[156:159], v[40:43]
  v_exp_f32 v4, v4
  ds_read_b64_tr_b16 v[30:31], v72 offset:25088
  v_mfma_f32_16x16x32_bf16 v[44:47], v[36:39], v[228:231], v[44:47]
  v_add_f32 v3, 1.0, v3
  v_add_f32 v4, 1.0, v4
  ds_read_b64_tr_b16 v[32:33], v72 offset:28672
  s_waitcnt lgkmcnt(5)
  v_mfma_f32_16x16x32_bf16 v[40:43], v[16:19], v[160:163], v[40:43]
  v_rcp_f32 v3, v3
  ds_read_b64_tr_b16 v[34:35], v72 offset:29184
  v_mfma_f32_16x16x32_bf16 v[44:47], v[16:19], v[232:235], v[44:47]
  v_rcp_f32 v4, v4
  ds_read_b64_tr_b16 v[36:37], v72 offset:32768
  v_mfma_f32_16x16x32_bf16 v[40:43], v[20:23], v[164:167], v[40:43]
  v_mul_f32 v3, v3, v52
  v_mul_f32 v4, v4, v53
  ds_read_b64_tr_b16 v[38:39], v72 offset:33280
  v_mfma_f32_16x16x32_bf16 v[44:47], v[20:23], v[236:239], v[44:47]
  v_fma_f32 v7, v54, v54, s86
  v_fma_f32 v8, v55, v55, s86
  s_waitcnt lgkmcnt(4)
  v_mfma_f32_16x16x32_bf16 v[40:43], v[24:27], v[168:171], v[40:43]
  v_mul_f32 v7, -v54, v7
  v_mul_f32 v8, -v55, v8
  v_mfma_f32_16x16x32_bf16 v[44:47], v[24:27], v[240:243], v[44:47]
  v_exp_f32 v7, v7
  v_mfma_f32_16x16x32_bf16 v[40:43], v[28:31], v[172:175], v[40:43]
  v_exp_f32 v8, v8
  v_mfma_f32_16x16x32_bf16 v[44:47], v[28:31], v[244:247], v[44:47]
  v_add_f32 v7, 1.0, v7
  v_add_f32 v8, 1.0, v8
  s_waitcnt lgkmcnt(2)
  v_mfma_f32_16x16x32_bf16 v[40:43], v[32:35], v[176:179], v[40:43]
  v_rcp_f32 v7, v7
  v_mfma_f32_16x16x32_bf16 v[44:47], v[32:35], v[248:251], v[44:47]
  v_rcp_f32 v8, v8
  s_waitcnt lgkmcnt(0)
  v_mfma_f32_16x16x32_bf16 v[40:43], v[36:39], v[180:183], v[40:43]
  v_mul_f32 v7, v7, v54
  v_mul_f32 v8, v8, v55
  v_mfma_f32_16x16x32_bf16 v[44:47], v[36:39], v[252:255], v[44:47]
  v_cvt_pk_bf16_f32 v98, v3, v4
  v_cvt_pk_bf16_f32 v99, v7, v8
  s_waitcnt vmcnt(3)
  s_barrier
  s_mov_b32 s45, 0x2020202
  v_and_b32 v4, s45, v110
  v_cmp_eq_u32 vcc, s45, v4
  s_nop 1
  s_cmp_eq_u64 vcc, exec
  s_cbranch_scc1 L_pk_done
  v_and_b32 v3, 7, v0
  v_lshlrev_b32 v3, 2, v3
  s_lshl_b32 s44, s39, 5
  v_add_u32 v3, s44, v3
  s_mov_b32 s46, 0
L_pk_loop:
  global_load_dword v4, v3, s[28:29] sc0 sc1
  s_waitcnt vmcnt(0)
  v_and_b32 v4, s45, v4
  v_cmp_eq_u32 vcc, s45, v4
  s_nop 1
  s_cmp_eq_u64 vcc, exec
  s_cbranch_scc1 L_pk_done
  s_add_u32 s46, s46, 1
  s_cmp_lt_u32 s46, 0x40000
  s_sleep 4
  s_cbranch_scc1 L_pk_loop
L_pk_done:
  v_lshlrev_b32 v9, 2, v0
  v_and_b32 v10, 3, v1
  v_mul_u32_u24 v10, 320, v10
  v_lshl_add_u32 v10, v2, 4, v10
  v_lshlrev_b32 v9, 2, v0
  buffer_load_dword v16, v9, s[24:27], s95 offen offset:0 sc0 sc1
  buffer_load_dword v17, v9, s[24:27], s95 offen offset:256 sc0 sc1
  buffer_load_dword v18, v9, s[24:27], s95 offen offset:512 sc0 sc1
  buffer_load_dword v19, v9, s[24:27], s95 offen offset:768 sc0 sc1
  buffer_load_dword v20, v9, s[24:27], s96 offen offset:0 sc0 sc1
  buffer_load_dword v21, v9, s[24:27], s96 offen offset:256 sc0 sc1
  buffer_load_dword v22, v9, s[24:27], s96 offen offset:512 sc0 sc1
  buffer_load_dword v23, v9, s[24:27], s96 offen offset:768 sc0 sc1
  buffer_load_dwordx4 v[24:27], v10, s[24:27], s97 offen sc0 sc1
  v_lshl_add_u32 v5, v0, 4, s90
  v_add_u32 v6, 40960, v5
  v_fma_f32 v3, v40, v40, s86
  v_fma_f32 v4, v41, v41, s86
  v_mul_f32 v3, -v40, v3
  v_mul_f32 v4, -v41, v4
  ds_write_b64 v5, v[56:57] offset:0
  v_exp_f32 v3, v3
  v_exp_f32 v4, v4
  ds_write_b64 v5, v[58:59] offset:1024
  v_add_f32 v3, 1.0, v3
  v_add_f32 v4, 1.0, v4
  v_rcp_f32 v3, v3
  ds_write_b64 v5, v[60:61] offset:8192
  v_rcp_f32 v4, v4
  v_mul_f32 v3, v3, v40
  v_mul_f32 v4, v4, v41
  ds_write_b64 v5, v[62:63] offset:9216
  v_fma_f32 v7, v42, v42, s86
  v_fma_f32 v8, v43, v43, s86
  v_mul_f32 v7, -v42, v7
  v_mul_f32 v8, -v43, v8
  ds_write_b64 v5, v[64:65] offset:16384
  v_exp_f32 v7, v7
  v_exp_f32 v8, v8
  ds_write_b64 v5, v[66:67] offset:17408
  v_add_f32 v7, 1.0, v7
  v_add_f32 v8, 1.0, v8
  v_rcp_f32 v7, v7
  ds_write_b64 v5, v[68:69] offset:24576
  v_rcp_f32 v8, v8
  v_mul_f32 v7, v7, v42
  v_mul_f32 v8, v8, v43
  ds_write_b64 v5, v[70:71] offset:25600
  v_cvt_pk_bf16_f32 v100, v3, v4
  v_cvt_pk_bf16_f32 v101, v7, v8
  v_fma_f32 v3, v44, v44, s86
  v_fma_f32 v4, v45, v45, s86
  ds_write_b64 v5, v[84:85] offset:32768
  v_mul_f32 v3, -v44, v3
  v_mul_f32 v4, -v45, v4
  v_exp_f32 v3, v3
  ds_write_b64 v5, v[86:87] offset:33792
  v_exp_f32 v4, v4
  v_add_f32 v3, 1.0, v3
  v_add_f32 v4, 1.0, v4
  ds_write_b64 v6, v[88:89] offset:0
  v_rcp_f32 v3, v3
  v_rcp_f32 v4, v4
  ds_write_b64 v6, v[90:91] offset:1024
  v_mul_f32 v3, v3, v44
  v_mul_f32 v4, v4, v45
  v_fma_f32 v7, v46, v46, s86
  v_fma_f32 v8, v47, v47, s86
  ds_write_b64 v6, v[92:93] offset:8192
  v_mul_f32 v7, -v46, v7
  v_mul_f32 v8, -v47, v8
  v_exp_f32 v7, v7
  ds_write_b64 v6, v[94:95] offset:9216
  v_exp_f32 v8, v8
  v_add_f32 v7, 1.0, v7
  v_add_f32 v8, 1.0, v8
  ds_write_b64 v6, v[96:97] offset:16384
  v_rcp_f32 v7, v7
  v_rcp_f32 v8, v8
  ds_write_b64 v6, v[98:99] offset:17408
  v_mul_f32 v7, v7, v46
  v_mul_f32 v8, v8, v47
  v_cvt_pk_bf16_f32 v102, v3, v4
  v_cvt_pk_bf16_f32 v103, v7, v8
  ds_write_b64 v6, v[100:101] offset:24576
  ds_write_b64 v6, v[102:103] offset:25600
  v_lshl_add_u32 v5, v0, 4, s91
  v_add_u32 v6, 40960, v5
  v_lshrrev_b32 v8, 2, v1
  v_lshl_add_u32 v8, v2, 2, v8
  v_and_b32 v7, 3, v1
  v_lshrrev_b32 v3, 1, v7
  v_lshlrev_b32 v3, 3, v3
  v_xor_b32 v8, v8, v3
  v_lshlrev_b32 v8, 3, v8
  v_lshl_add_u32 v7, v7, 7, v8
  v_add_u32 v7, s92, v7
  s_waitcnt vmcnt(0)
  v_cvt_pk_bf16_f32 v28, v16, v17
  v_cvt_pk_bf16_f32 v29, v18, v19
  v_cvt_pk_bf16_f32 v30, v20, v21
  v_cvt_pk_bf16_f32 v31, v22, v23
  v_cvt_pk_bf16_f32 v32, v24, v25
  v_cvt_pk_bf16_f32 v33, v26, v27
  v_lshlrev_b32 v9, 3, v0
  v_add_u32 v10, s98, v9
  ds_write_b64 v10, v[28:29]
  v_add_u32 v10, s99, v9
  ds_write_b64 v10, v[30:31]
  v_add_u32 v10, s3, v9
  ds_write_b64 v10, v[32:33]
  s_load_dwordx2 s[32:33], s[0:1], 56
  s_load_dwordx2 s[34:35], s[0:1], 64
  s_waitcnt lgkmcnt(0)
  s_mov_b32 s12, s32
  s_and_b32 s13, s33, 0xffff
  s_mov_b32 s14, 1152
  s_mov_b32 s15, 0x20000
  s_mov_b32 s8, s34
  s_and_b32 s9, s35, 0xffff
  s_mov_b32 s10, 2359296
  s_mov_b32 s11, 0x20000
  s_barrier
  s_mov_b32 s95, 1024
  v_add_u32 v10, 45056, v9
  ds_read_b64 v[46:47], v10 offset:7168
  ds_read_b64 v[48:49], v10 offset:7680
  v_add_u32 v8, 126976, v9
  ds_read_b64 v[50:51], v8 offset:0
  ds_read_b64 v[52:53], v8 offset:512
  ds_read_b64 v[54:55], v8 offset:1024
  ds_read_b64 v[102:103], v10 offset:5120
  ds_read_b64 v[44:45], v10 offset:6144
  v_add_u32 v8, s66, v9
  ds_read_b64 v[96:97], v8
  v_add_u32 v8, s67, v9
  ds_read_b64 v[98:99], v8
  v_add_u32 v8, s68, v9
  ds_read_b64 v[100:101], v8
  ds_read_b64_tr_b16 v[60:61], v7 offset:2560
  ds_read_b64_tr_b16 v[62:63], v7 offset:3072
  ds_read_b64_tr_b16 v[64:65], v7 offset:3584
  ds_read_b64_tr_b16 v[66:67], v7 offset:4096
  ds_read_b64_tr_b16 v[68:69], v7 offset:4608
  ds_read_b64_tr_b16 v[70:71], v7 offset:5120
  ds_read_b64_tr_b16 v[72:73], v7 offset:5632
  ds_read_b64_tr_b16 v[74:75], v7 offset:6144
  ds_read_b64_tr_b16 v[76:77], v7 offset:6656
  ds_read_b64_tr_b16 v[78:79], v7 offset:7168
  s_lshl_b32 s44, s38, 2
  s_lshr_b32 s44, 8448, s44
  s_and_b32 s44, s44, 15
  s_lshl_b32 s44, s44, 10
  v_add_u32 v8, s44, v7
  ds_read_b64_tr_b16 v[84:85], v8 offset:2560
  ds_read_b64_tr_b16 v[86:87], v8 offset:3072
  s_lshl_b32 s44, s38, 2
  s_lshr_b32 s44, 12816, s44
  s_and_b32 s44, s44, 15
  s_lshl_b32 s44, s44, 10
  v_add_u32 v8, s44, v7
  ds_read_b64_tr_b16 v[88:89], v8 offset:2560
  ds_read_b64_tr_b16 v[90:91], v8 offset:3072
  s_lshl_b32 s44, s38, 2
  s_lshr_b32 s44, 17185, s44
  s_and_b32 s44, s44, 15
  s_lshl_b32 s44, s44, 10
  v_add_u32 v8, s44, v7
  ds_read_b64_tr_b16 v[92:93], v8 offset:2560
  ds_read_b64_tr_b16 v[94:95], v8 offset:3072
  ds_read_b128 v[112:115], v5 offset:0
  ds_read_b128 v[116:119], v5 offset:1024
  ds_read_b128 v[120:123], v5 offset:4096
  ds_read_b128 v[124:127], v5 offset:5120
  ds_read_b128 v[128:131], v5 offset:8192
  ds_read_b128 v[132:135], v5 offset:9216
  ds_read_b128 v[136:139], v5 offset:12288
  ds_read_b128 v[140:143], v5 offset:13312
  ds_read_b128 v[144:147], v5 offset:16384
  ds_read_b128 v[148:151], v5 offset:17408
  ds_read_b128 v[152:155], v5 offset:20480
  ds_read_b128 v[156:159], v5 offset:21504
  ds_read_b128 v[160:163], v5 offset:24576
  ds_read_b128 v[164:167], v5 offset:25600
  ds_read_b128 v[168:171], v5 offset:28672
  ds_read_b128 v[172:175], v5 offset:29696
  ds_read_b128 v[176:179], v5 offset:32768
  ds_read_b128 v[180:183], v5 offset:33792
  ds_read_b128 v[184:187], v5 offset:36864
  ds_read_b128 v[188:191], v5 offset:37888
  ds_read_b128 v[192:195], v6 offset:0
  ds_read_b128 v[196:199], v6 offset:1024
  ds_read_b128 v[200:203], v6 offset:4096
  ds_read_b128 v[204:207], v6 offset:5120
  ds_read_b128 v[208:211], v6 offset:8192
  ds_read_b128 v[212:215], v6 offset:9216
  ds_read_b128 v[216:219], v6 offset:12288
  s_waitcnt lgkmcnt(15)
  v_mfma_f32_16x16x16_bf16 v[16:19], v[46:47], v[60:61], 0
  v_mfma_f32_16x16x16_bf16 v[16:19], v[48:49], v[64:65], v[16:19]
  v_mfma_f32_16x16x16_bf16 v[16:19], v[50:51], v[68:69], v[16:19]
  v_mfma_f32_16x16x16_bf16 v[16:19], v[52:53], v[72:73], v[16:19]
  v_mfma_f32_16x16x16_bf16 v[16:19], v[54:55], v[76:77], v[16:19]
  v_mfma_f32_16x16x16_bf16 v[20:23], v[46:47], v[62:63], 0
  v_mfma_f32_16x16x16_bf16 v[20:23], v[48:49], v[66:67], v[20:23]
  v_mfma_f32_16x16x16_bf16 v[20:23], v[50:51], v[70:71], v[20:23]
  v_mfma_f32_16x16x16_bf16 v[20:23], v[52:53], v[74:75], v[20:23]
  v_mfma_f32_16x16x16_bf16 v[20:23], v[54:55], v[78:79], v[20:23]
  v_mfma_f32_16x16x16_bf16 v[24:27], v[96:97], v[84:85], 0
  v_mfma_f32_16x16x16_bf16 v[24:27], v[98:99], v[88:89], v[24:27]
  v_mfma_f32_16x16x16_bf16 v[24:27], v[100:101], v[92:93], v[24:27]
  v_mfma_f32_16x16x16_bf16 v[32:35], v[102:103], v[72:73], 0
  v_mfma_f32_16x16x16_bf16 v[32:35], v[44:45], v[76:77], v[32:35]
  v_mfma_f32_16x16x16_bf16 v[28:31], v[96:97], v[86:87], 0
  v_mfma_f32_16x16x16_bf16 v[28:31], v[98:99], v[90:91], v[28:31]
  v_mfma_f32_16x16x16_bf16 v[28:31], v[100:101], v[94:95], v[28:31]
  v_mfma_f32_16x16x16_bf16 v[36:39], v[102:103], v[74:75], 0
  v_mfma_f32_16x16x16_bf16 v[36:39], v[44:45], v[78:79], v[36:39]
  ds_read_b128 v[220:223], v6 offset:13312
  ds_read_b128 v[224:227], v6 offset:16384
  ds_read_b128 v[228:231], v6 offset:17408
  ds_read_b128 v[232:235], v6 offset:20480
  ds_read_b128 v[236:239], v6 offset:21504
  ds_read_b128 v[240:243], v6 offset:24576
  ds_read_b128 v[244:247], v6 offset:25600
  ds_read_b128 v[248:251], v6 offset:28672
  ds_read_b128 v[252:255], v6 offset:29696
  v_add_f32 v16, 0x358637bd, v16
  v_add_f32 v17, 0x358637bd, v17
  v_add_f32 v18, 0x358637bd, v18
  v_add_f32 v19, 0x358637bd, v19
  v_rcp_f32 v16, v16
  v_rcp_f32 v17, v17
  v_rcp_f32 v18, v18
  v_rcp_f32 v19, v19
  v_mul_f32 v16, 0x3eeff558, v16
  v_mul_f32 v17, 0x3eeff558, v17
  v_mul_f32 v18, 0x3eeff558, v18
  v_mul_f32 v19, 0x3eeff558, v19
  v_add_f32 v20, 0x358637bd, v20
  v_add_f32 v21, 0x358637bd, v21
  v_add_f32 v22, 0x358637bd, v22
  v_add_f32 v23, 0x358637bd, v23
  v_rcp_f32 v20, v20
  v_rcp_f32 v21, v21
  v_rcp_f32 v22, v22
  v_rcp_f32 v23, v23
  v_mul_f32 v20, 0x3eeff558, v20
  v_mul_f32 v21, 0x3eeff558, v21
  v_mul_f32 v22, 0x3eeff558, v22
  v_mul_f32 v23, 0x3eeff558, v23
  s_cmp_eq_u32 s38, 2
  s_cselect_b64 s[70:71], -1, 0
  s_cmp_eq_u32 s38, 3
  s_cselect_b64 s[72:73], -1, 0
  v_mov_b32 v40, v16
  v_mov_b32 v41, v17
  v_cndmask_b32 v40, v40, v17, s[70:71]
  v_cndmask_b32 v41, v41, v18, s[70:71]
  v_cndmask_b32 v40, v40, v18, s[72:73]
  v_cndmask_b32 v41, v41, v19, s[72:73]
  v_mov_b32 v42, v20
  v_mov_b32 v43, v21
  v_cndmask_b32 v42, v42, v21, s[70:71]
  v_cndmask_b32 v43, v43, v22, s[70:71]
  v_cndmask_b32 v42, v42, v22, s[72:73]
  v_cndmask_b32 v43, v43, v23, s[72:73]
  s_lshl_b32 s44, s38, 3
  s_lshr_b32 s44, 100925970, s44
  s_and_b32 s44, s44, 255
  v_lshlrev_b32 v4, 2, v2
  v_add_u32 v3, 0, v4
  v_cmp_le_u32 s[74:75], s44, v3
  s_nop 1
  v_cndmask_b32 v7, v40, v41, s[74:75]
  v_cndmask_b32 v8, v42, v43, s[74:75]
  v_mul_f32 v24, v24, v7
  v_mul_f32 v28, v28, v8
  v_add_u32 v3, 1, v4
  v_cmp_le_u32 s[76:77], s44, v3
  s_nop 1
  v_cndmask_b32 v7, v40, v41, s[76:77]
  v_cndmask_b32 v8, v42, v43, s[76:77]
  v_mul_f32 v25, v25, v7
  v_mul_f32 v29, v29, v8
  v_add_u32 v3, 2, v4
  v_cmp_le_u32 s[74:75], s44, v3
  s_nop 1
  v_cndmask_b32 v7, v40, v41, s[74:75]
  v_cndmask_b32 v8, v42, v43, s[74:75]
  v_mul_f32 v26, v26, v7
  v_mul_f32 v30, v30, v8
  v_add_u32 v3, 3, v4
  v_cmp_le_u32 s[76:77], s44, v3
  s_nop 1
  v_cndmask_b32 v7, v40, v41, s[76:77]
  v_cndmask_b32 v8, v42, v43, s[76:77]
  v_mul_f32 v27, v27, v7
  v_mul_f32 v31, v31, v8
  v_mul_f32 v32, v32, v19
  v_mul_f32 v33, v33, v19
  v_mul_f32 v34, v34, v19
  v_mul_f32 v35, v35, v19
  v_mul_f32 v36, v36, v23
  v_mul_f32 v37, v37, v23
  v_mul_f32 v38, v38, v23
  v_mul_f32 v39, v39, v23
  v_cvt_pk_bf16_f32 v44, v24, v25
  v_cvt_pk_bf16_f32 v45, v26, v27
  v_cvt_pk_bf16_f32 v48, v32, v33
  v_cvt_pk_bf16_f32 v49, v34, v35
  v_cvt_pk_bf16_f32 v46, v28, v29
  v_cvt_pk_bf16_f32 v47, v30, v31
  v_cvt_pk_bf16_f32 v50, v36, v37
  v_cvt_pk_bf16_f32 v51, v38, v39
  s_add_u32 s44, s88, 159744
  s_add_u32 s45, s88, 8704
  s_cmp_lt_u32 s36, 4
  s_cselect_b32 s44, s44, s45
  s_cmp_eq_u32 s36, 7
  s_cselect_b32 s44, 0, s44
  v_lshl_add_u32 v3, v0, 4, s44
  ds_write_b128 v3, v[44:47]
  s_waitcnt lgkmcnt(0)
  s_barrier
  s_add_u32 m0, s88, 45056
  s_nop 0
  buffer_load_dwordx4 v13, s[16:19], s85 offen offset:0 lds
  s_add_u32 m0, s88, 53248
  s_nop 0
  buffer_load_dwordx4 v13, s[16:19], s89 offen offset:0 lds
  s_add_u32 m0, s88, 61440
  s_nop 0
  buffer_load_dwordx4 v14, s[20:23], 0 offen offset:0 lds
  s_add_u32 m0, s88, 69632
  s_cmp_ge_u32 s36, 1
  s_cbranch_scc1 L_d30
  buffer_load_dwordx4 v14, s[20:23], s61 offen offset:0 lds
L_d30:
  s_cmp_eq_u32 s37, 0
  s_mov_b32 s45, 12800
  s_cselect_b32 s44, 159744, s45
  v_lshl_add_u32 v3, v0, 4, s44
  s_mov_b32 s45, 0
  s_cselect_b32 s44, 162816, s45
  v_lshl_add_u32 v4, v0, 4, s44
  ds_read_b64 v[84:85], v3 offset:0
  ds_read_b64 v[94:95], v3 offset:8
  ds_read_b64 v[86:87], v3 offset:1024
  ds_read_b64 v[96:97], v3 offset:1032
  ds_read_b64 v[88:89], v3 offset:2048
  ds_read_b64 v[98:99], v3 offset:2056
  ds_read_b64 v[90:91], v4 offset:0
  ds_read_b64 v[100:101], v4 offset:8
  v_mov_b32 v92, v48
  v_mov_b32 v93, v49
  v_mov_b32 v102, v50
  v_mov_b32 v103, v51
  v_lshrrev_b32 v3, 2, v1
  v_lshl_add_u32 v3, v2, 2, v3
  v_and_b32 v4, 6, v3
  v_bfe_u32 v5, v0, 1, 1
  s_lshl_b32 s44, s38, 1
  v_or_b32 v5, s44, v5
  v_xor_b32 v5, v5, v4
  v_lshlrev_b32 v5, 4, v5
  v_lshl_add_u32 v5, v3, 7, v5
  v_and_b32 v4, 1, v0
  v_lshl_add_u32 v73, v4, 3, v5
  v_lshrrev_b32 v4, 1, v2
  v_lshlrev_b32 v4, 10, v4
  v_sub_u32 v75, v73, v4
  v_lshlrev_b32 v76, 4, v0
  s_mul_i32 s44, s40, 589824
  s_lshl_b32 s45, s36, 13
  s_add_u32 s44, s44, s45
  s_lshl_b32 s45, s39, 10
  s_add_u32 s44, s44, s45
  s_add_u32 s84, s44, 0
  v_add_u32 v72, 131072, v73
  ds_read_b64_tr_b16 v[16:17], v72 offset:0
  ds_read_b64_tr_b16 v[18:19], v72 offset:2048
  ds_read_b64_tr_b16 v[20:21], v72 offset:4096
  ds_read_b64_tr_b16 v[22:23], v72 offset:6144
  ds_read_b64_tr_b16 v[24:25], v72 offset:8192
  ds_read_b64_tr_b16 v[26:27], v72 offset:10240
  ds_read_b64_tr_b16 v[28:29], v72 offset:12288
  ds_read_b64_tr_b16 v[30:31], v72 offset:14336
  ds_read_b64_tr_b16 v[32:33], v72 offset:16384
  ds_read_b64_tr_b16 v[34:35], v72 offset:18432
  s_waitcnt lgkmcnt(6)
  v_mfma_f32_16x16x32_bf16 v[40:43], v[16:19], v[112:115], 0
  s_add_u32 m0, s88, 73728
  s_add_u32 s45, s39, 1
  s_and_b32 s45, s45, 7
  s_lshl_b32 s45, s45, 7
  s_sub_u32 s96, s45, s95
  s_mov_b32 s95, s45
  v_add_u32 v13, s96, v13
  v_add_u32 v14, s96, v14
  ds_read_b64_tr_b16 v[36:37], v72 offset:20480
  buffer_load_dwordx4 v13, s[16:19], s60 offen offset:0 lds
  v_mfma_f32_16x16x32_bf16 v[44:47], v[16:19], v[116:119], 0
  ds_read_b64_tr_b16 v[38:39], v72 offset:22528
  v_mfma_f32_16x16x32_bf16 v[40:43], v[20:23], v[120:123], v[40:43]
  s_add_u32 m0, s88, 81920
  ds_read_b64_tr_b16 v[16:17], v72 offset:24576
  buffer_load_dwordx4 v13, s[16:19], s61 offen offset:0 lds
  v_mfma_f32_16x16x32_bf16 v[44:47], v[20:23], v[124:127], v[44:47]
  ds_read_b64_tr_b16 v[18:19], v72 offset:26624
  s_barrier
  v_add_u32 v72, 16384, v73
  s_waitcnt lgkmcnt(6)
  v_mfma_f32_16x16x32_bf16 v[40:43], v[24:27], v[128:131], v[40:43]
  s_add_u32 m0, s88, 90112
  ds_read_b64_tr_b16 v[20:21], v72 offset:0
  buffer_load_dwordx4 v13, s[16:19], s62 offen offset:0 lds
  v_mfma_f32_16x16x32_bf16 v[44:47], v[24:27], v[132:135], v[44:47]
  ds_read_b64_tr_b16 v[22:23], v72 offset:2048
  v_mfma_f32_16x16x32_bf16 v[40:43], v[28:31], v[136:139], v[40:43]
  s_add_u32 m0, s88, 98304
  ds_read_b64_tr_b16 v[24:25], v72 offset:4096
  s_cmp_eq_u32 s37, 1
  s_cselect_b64 vcc, -1, 0
  s_cbranch_vccnz L_d31
  buffer_load_dwordx4 v13, s[16:19], s63 offen offset:0 lds
L_d31:
  v_mfma_f32_16x16x32_bf16 v[44:47], v[28:31], v[140:143], v[44:47]
  ds_read_b64_tr_b16 v[26:27], v72 offset:6144
  s_waitcnt lgkmcnt(6)
  v_mfma_f32_16x16x32_bf16 v[40:43], v[32:35], v[144:147], v[40:43]
  ds_read_b64_tr_b16 v[28:29], v72 offset:8192
  v_mfma_f32_16x16x32_bf16 v[44:47], v[32:35], v[148:151], v[44:47]
  ds_read_b64_tr_b16 v[30:31], v72 offset:10240
  v_mfma_f32_16x16x32_bf16 v[40:43], v[36:39], v[152:155], v[40:43]
  ds_read_b64_tr_b16 v[32:33], v72 offset:12288
  v_mfma_f32_16x16x32_bf16 v[44:47], v[36:39], v[156:159], v[44:47]
  ds_read_b64_tr_b16 v[34:35], v72 offset:14336
  s_waitcnt lgkmcnt(6)
  v_mfma_f32_16x16x32_bf16 v[40:43], v[16:19], v[160:163], v[40:43]
  ds_read_b64_tr_b16 v[36:37], v72 offset:16384
  v_mfma_f32_16x16x32_bf16 v[44:47], v[16:19], v[164:167], v[44:47]
  ds_read_b64_tr_b16 v[38:39], v72 offset:18432
  v_mfma_f32_16x16x32_bf16 v[40:43], v[20:23], v[168:171], v[40:43]
  s_add_u32 m0, s88, 102400
  ds_read_b64_tr_b16 v[16:17], v72 offset:20480
  buffer_load_dwordx4 v13, s[16:19], s41 offen offset:0 lds
  v_mfma_f32_16x16x32_bf16 v[44:47], v[20:23], v[172:175], v[44:47]
  ds_read_b64_tr_b16 v[18:19], v72 offset:22528
  s_waitcnt lgkmcnt(6)
  v_mfma_f32_16x16x32_bf16 v[40:43], v[24:27], v[176:179], v[40:43]
  s_add_u32 m0, s88, 110592
  ds_read_b64_tr_b16 v[20:21], v72 offset:24576
  buffer_load_dwordx4 v13, s[16:19], s42 offen offset:0 lds
  v_mfma_f32_16x16x32_bf16 v[44:47], v[24:27], v[180:183], v[44:47]
  ds_read_b64_tr_b16 v[22:23], v72 offset:26624
  s_waitcnt vmcnt(5)
  s_barrier
  v_add_u32 v72, 45056, v73
  v_add_u32 v74, 45056, v75
  v_mfma_f32_16x16x32_bf16 v[40:43], v[28:31], v[184:187], v[40:43]
  s_add_u32 m0, s88, 118784
  ds_read_b64_tr_b16 v[24:25], v72 offset:0
  buffer_load_dwordx4 v13, s[16:19], s43 offen offset:0 lds
  v_mfma_f32_16x16x32_bf16 v[44:47], v[28:31], v[188:191], v[44:47]
  ds_read_b64_tr_b16 v[26:27], v72 offset:2048
  s_waitcnt lgkmcnt(6)
  v_mfma_f32_16x16x32_bf16 v[40:43], v[32:35], v[192:195], v[40:43]
  s_add_u32 m0, s88, 126976
  ds_read_b64_tr_b16 v[28:29], v72 offset:4096
  s_cbranch_vccnz L_d32
  buffer_load_dwordx4 v13, s[16:19], s65 offen offset:0 lds
L_d32:
  v_mfma_f32_16x16x32_bf16 v[44:47], v[32:35], v[196:199], v[44:47]
  ds_read_b64_tr_b16 v[30:31], v72 offset:6144
  v_mfma_f32_16x16x32_bf16 v[40:43], v[36:39], v[200:203], v[40:43]
  ds_read_b64_tr_b16 v[32:33], v72 offset:8192
  v_mfma_f32_16x16x32_bf16 v[44:47], v[36:39], v[204:207], v[44:47]
  ds_read_b64_tr_b16 v[34:35], v72 offset:10240
  s_waitcnt lgkmcnt(6)
  v_mfma_f32_16x16x32_bf16 v[40:43], v[16:19], v[208:211], v[40:43]
  ds_read_b64_tr_b16 v[36:37], v72 offset:12288
  v_mfma_f32_16x16x32_bf16 v[44:47], v[16:19], v[212:215], v[44:47]
  ds_read_b64_tr_b16 v[38:39], v72 offset:14336
  v_mfma_f32_16x16x32_bf16 v[40:43], v[20:23], v[216:219], v[40:43]
  ds_read_b64_tr_b16 v[16:17], v72 offset:16384
  v_mfma_f32_16x16x32_bf16 v[44:47], v[20:23], v[220:223], v[44:47]
  ds_read_b64_tr_b16 v[18:19], v72 offset:18432
  s_waitcnt lgkmcnt(6)
  v_mfma_f32_16x16x32_bf16 v[40:43], v[24:27], v[224:227], v[40:43]
  s_add_u32 m0, s88, 131072
  ds_read_b64_tr_b16 v[20:21], v72 offset:20480
  buffer_load_dwordx4 v13, s[16:19], s85 offen offset:0 lds
  v_mfma_f32_16x16x32_bf16 v[44:47], v[24:27], v[228:231], v[44:47]
  ds_read_b64_tr_b16 v[22:23], v72 offset:22528
  v_mfma_f32_16x16x32_bf16 v[40:43], v[28:31], v[232:235], v[40:43]
  s_add_u32 m0, s88, 139264
  ds_read_b64_tr_b16 v[24:25], v74 offset:24576
  buffer_load_dwordx4 v13, s[16:19], s89 offen offset:0 lds
  v_mfma_f32_16x16x32_bf16 v[44:47], v[28:31], v[236:239], v[44:47]
  s_waitcnt vmcnt(5)
  s_barrier
  v_add_u32 v72, 73728, v73
  s_waitcnt lgkmcnt(5)
  v_mfma_f32_16x16x32_bf16 v[40:43], v[32:35], v[240:243], v[40:43]
  s_add_u32 m0, s88, 147456
  ds_read_b64_tr_b16 v[28:29], v72 offset:0
  buffer_load_dwordx4 v14, s[20:23], 0 offen offset:0 lds
  v_mfma_f32_16x16x32_bf16 v[44:47], v[32:35], v[244:247], v[44:47]
  ds_read_b64_tr_b16 v[30:31], v72 offset:2048
  v_mfma_f32_16x16x32_bf16 v[40:43], v[36:39], v[248:251], v[40:43]
  s_add_u32 m0, s88, 155648
  ds_read_b64_tr_b16 v[32:33], v72 offset:4096
  s_cmp_ge_u32 s36, 1
  s_cbranch_scc1 L_d33
  buffer_load_dwordx4 v14, s[20:23], s61 offen offset:0 lds
L_d33:
  v_mfma_f32_16x16x32_bf16 v[44:47], v[36:39], v[252:255], v[44:47]
  ds_read_b64_tr_b16 v[34:35], v72 offset:6144
  s_waitcnt lgkmcnt(5)
  v_mfma_f32_16x16x32_bf16 v[40:43], v[16:19], v[84:87], v[40:43]
  ds_read_b64_tr_b16 v[36:37], v72 offset:8192
  v_mfma_f32_16x16x32_bf16 v[44:47], v[16:19], v[94:97], v[44:47]
  ds_read_b64_tr_b16 v[38:39], v72 offset:10240
  v_mfma_f32_16x16x32_bf16 v[40:43], v[20:23], v[88:91], v[40:43]
  ds_read_b64_tr_b16 v[16:17], v72 offset:12288
  v_mfma_f32_16x16x32_bf16 v[44:47], v[20:23], v[98:101], v[44:47]
  ds_read_b64_tr_b16 v[18:19], v72 offset:14336
  s_waitcnt lgkmcnt(6)
  v_mfma_f32_16x16x16_bf16 v[40:43], v[24:25], v[92:93], v[40:43]
  ds_read_b64_tr_b16 v[20:21], v72 offset:16384
  v_mfma_f32_16x16x16_bf16 v[44:47], v[24:25], v[102:103], v[44:47]
  ds_read_b64_tr_b16 v[22:23], v72 offset:18432
  v_mfma_f32_16x16x32_bf16 v[48:51], v[28:31], v[112:115], 0
  s_add_u32 m0, s88, 16384
  s_add_u32 s45, s39, 2
  s_and_b32 s45, s45, 7
  s_lshl_b32 s45, s45, 7
  s_sub_u32 s96, s45, s95
  s_mov_b32 s95, s45
  v_add_u32 v13, s96, v13
  v_add_u32 v14, s96, v14
  ds_read_b64_tr_b16 v[24:25], v72 offset:20480
  buffer_load_dwordx4 v13, s[16:19], s60 offen offset:0 lds
  v_mfma_f32_16x16x32_bf16 v[52:55], v[28:31], v[116:119], 0
  ds_read_b64_tr_b16 v[26:27], v72 offset:22528
  s_waitcnt lgkmcnt(6)
  v_mfma_f32_16x16x32_bf16 v[48:51], v[32:35], v[120:123], v[48:51]
  s_add_u32 m0, s88, 24576
  ds_read_b64_tr_b16 v[28:29], v72 offset:24576
  buffer_load_dwordx4 v13, s[16:19], s61 offen offset:0 lds
  v_mfma_f32_16x16x32_bf16 v[52:55], v[32:35], v[124:127], v[52:55]
  v_cvt_pk_bf16_f32 v80, v40, v41
  v_cvt_pk_bf16_f32 v81, v42, v43
  ds_read_b64_tr_b16 v[30:31], v72 offset:26624
  s_waitcnt vmcnt(5)
  s_barrier
  v_add_u32 v72, 102400, v73
  v_mfma_f32_16x16x32_bf16 v[48:51], v[36:39], v[128:131], v[48:51]
  s_add_u32 m0, s88, 32768
  v_cvt_pk_bf16_f32 v82, v44, v45
  v_cvt_pk_bf16_f32 v83, v46, v47
  ds_read_b64_tr_b16 v[32:33], v72 offset:0
  buffer_load_dwordx4 v13, s[16:19], s62 offen offset:0 lds
  v_mfma_f32_16x16x32_bf16 v[52:55], v[36:39], v[132:135], v[52:55]
  ds_read_b64_tr_b16 v[34:35], v72 offset:2048
  s_waitcnt lgkmcnt(6)
  v_mfma_f32_16x16x32_bf16 v[48:51], v[16:19], v[136:139], v[48:51]
  s_add_u32 m0, s88, 40960
  s_add_u32 s44, s84, 524288
  buffer_store_dwordx4 v[80:83], v76, s[24:27], s44 offen sc1
  ds_read_b64_tr_b16 v[36:37], v72 offset:4096
  s_cbranch_vccnz L_d34
  buffer_load_dwordx4 v13, s[16:19], s63 offen offset:0 lds
L_d34:
  v_mfma_f32_16x16x32_bf16 v[52:55], v[16:19], v[140:143], v[52:55]
  ds_read_b64_tr_b16 v[38:39], v72 offset:6144
  v_mfma_f32_16x16x32_bf16 v[48:51], v[20:23], v[144:147], v[48:51]
  ds_read_b64_tr_b16 v[16:17], v72 offset:8192
  v_mfma_f32_16x16x32_bf16 v[52:55], v[20:23], v[148:151], v[52:55]
  ds_read_b64_tr_b16 v[18:19], v72 offset:10240
  s_waitcnt lgkmcnt(6)
  v_mfma_f32_16x16x32_bf16 v[48:51], v[24:27], v[152:155], v[48:51]
  ds_read_b64_tr_b16 v[20:21], v72 offset:12288
  v_mfma_f32_16x16x32_bf16 v[52:55], v[24:27], v[156:159], v[52:55]
  ds_read_b64_tr_b16 v[22:23], v72 offset:14336
  v_mfma_f32_16x16x32_bf16 v[48:51], v[28:31], v[160:163], v[48:51]
  ds_read_b64_tr_b16 v[24:25], v72 offset:16384
  v_mfma_f32_16x16x32_bf16 v[52:55], v[28:31], v[164:167], v[52:55]
  ds_read_b64_tr_b16 v[26:27], v72 offset:18432
  s_waitcnt lgkmcnt(6)
  v_mfma_f32_16x16x32_bf16 v[48:51], v[32:35], v[168:171], v[48:51]
  s_add_u32 m0, s88, 45056
  ds_read_b64_tr_b16 v[28:29], v72 offset:20480
  buffer_load_dwordx4 v13, s[16:19], s41 offen offset:0 lds
  v_mfma_f32_16x16x32_bf16 v[52:55], v[32:35], v[172:175], v[52:55]
  ds_read_b64_tr_b16 v[30:31], v72 offset:22528
  v_mfma_f32_16x16x32_bf16 v[48:51], v[36:39], v[176:179], v[48:51]
  s_add_u32 m0, s88, 53248
  ds_read_b64_tr_b16 v[32:33], v72 offset:24576
  buffer_load_dwordx4 v13, s[16:19], s42 offen offset:0 lds
  v_mfma_f32_16x16x32_bf16 v[52:55], v[36:39], v[180:183], v[52:55]
  ds_read_b64_tr_b16 v[34:35], v72 offset:26624
  s_waitcnt vmcnt(6)
  s_barrier
  v_add_u32 v72, 131072, v73
  v_add_u32 v74, 131072, v75
  s_waitcnt lgkmcnt(6)
  v_mfma_f32_16x16x32_bf16 v[48:51], v[16:19], v[184:187], v[48:51]
  s_add_u32 m0, s88, 61440
  ds_read_b64_tr_b16 v[36:37], v72 offset:0
  buffer_load_dwordx4 v13, s[16:19], s43 offen offset:0 lds
  v_mfma_f32_16x16x32_bf16 v[52:55], v[16:19], v[188:191], v[52:55]
  ds_read_b64_tr_b16 v[38:39], v72 offset:2048
  v_mfma_f32_16x16x32_bf16 v[48:51], v[20:23], v[192:195], v[48:51]
  s_add_u32 m0, s88, 69632
  ds_read_b64_tr_b16 v[16:17], v72 offset:4096
  s_cbranch_vccnz L_d35
  buffer_load_dwordx4 v13, s[16:19], s65 offen offset:0 lds
L_d35:
  v_mfma_f32_16x16x32_bf16 v[52:55], v[20:23], v[196:199], v[52:55]
  ds_read_b64_tr_b16 v[18:19], v72 offset:6144
  s_waitcnt lgkmcnt(6)
  v_mfma_f32_16x16x32_bf16 v[48:51], v[24:27], v[200:203], v[48:51]
  ds_read_b64_tr_b16 v[20:21], v72 offset:8192
  v_mfma_f32_16x16x32_bf16 v[52:55], v[24:27], v[204:207], v[52:55]
  ds_read_b64_tr_b16 v[22:23], v72 offset:10240
  v_mfma_f32_16x16x32_bf16 v[48:51], v[28:31], v[208:211], v[48:51]
  ds_read_b64_tr_b16 v[24:25], v72 offset:12288
  v_mfma_f32_16x16x32_bf16 v[52:55], v[28:31], v[212:215], v[52:55]
  ds_read_b64_tr_b16 v[26:27], v72 offset:14336
  s_waitcnt lgkmcnt(6)
  v_mfma_f32_16x16x32_bf16 v[48:51], v[32:35], v[216:219], v[48:51]
  ds_read_b64_tr_b16 v[28:29], v72 offset:16384
  v_mfma_f32_16x16x32_bf16 v[52:55], v[32:35], v[220:223], v[52:55]
  ds_read_b64_tr_b16 v[30:31], v72 offset:18432
  v_mfma_f32_16x16x32_bf16 v[48:51], v[36:39], v[224:227], v[48:51]
  s_add_u32 m0, s88, 73728
  ds_read_b64_tr_b16 v[32:33], v72 offset:20480
  buffer_load_dwordx4 v13, s[16:19], s85 offen offset:0 lds
  v_mfma_f32_16x16x32_bf16 v[52:55], v[36:39], v[228:231], v[52:55]
  ds_read_b64_tr_b16 v[34:35], v72 offset:22528
  s_waitcnt lgkmcnt(6)
  v_mfma_f32_16x16x32_bf16 v[48:51], v[16:19], v[232:235], v[48:51]
  s_add_u32 m0, s88, 81920
  ds_read_b64_tr_b16 v[36:37], v74 offset:24576
  buffer_load_dwordx4 v13, s[16:19], s89 offen offset:0 lds
  v_mfma_f32_16x16x32_bf16 v[52:55], v[16:19], v[236:239], v[52:55]
  s_waitcnt vmcnt(6)
  s_barrier
  v_add_u32 v72, 16384, v73
  v_mfma_f32_16x16x32_bf16 v[48:51], v[20:23], v[240:243], v[48:51]
  s_add_u32 m0, s88, 90112
  ds_read_b64_tr_b16 v[16:17], v72 offset:0
  buffer_load_dwordx4 v14, s[20:23], 0 offen offset:0 lds
  v_mfma_f32_16x16x32_bf16 v[52:55], v[20:23], v[244:247], v[52:55]
  ds_read_b64_tr_b16 v[18:19], v72 offset:2048
  s_waitcnt lgkmcnt(5)
  v_mfma_f32_16x16x32_bf16 v[48:51], v[24:27], v[248:251], v[48:51]
  s_add_u32 m0, s88, 98304
  ds_read_b64_tr_b16 v[20:21], v72 offset:4096
  s_cmp_ge_u32 s36, 1
  s_cbranch_scc1 L_d36
  buffer_load_dwordx4 v14, s[20:23], s61 offen offset:0 lds
L_d36:
  v_mfma_f32_16x16x32_bf16 v[52:55], v[24:27], v[252:255], v[52:55]
  ds_read_b64_tr_b16 v[22:23], v72 offset:6144
  v_mfma_f32_16x16x32_bf16 v[48:51], v[28:31], v[84:87], v[48:51]
  ds_read_b64_tr_b16 v[24:25], v72 offset:8192
  v_mfma_f32_16x16x32_bf16 v[52:55], v[28:31], v[94:97], v[52:55]
  ds_read_b64_tr_b16 v[26:27], v72 offset:10240
  s_waitcnt lgkmcnt(6)
  v_mfma_f32_16x16x32_bf16 v[48:51], v[32:35], v[88:91], v[48:51]
  ds_read_b64_tr_b16 v[28:29], v72 offset:12288
  v_mfma_f32_16x16x32_bf16 v[52:55], v[32:35], v[98:101], v[52:55]
  ds_read_b64_tr_b16 v[30:31], v72 offset:14336
  v_mfma_f32_16x16x16_bf16 v[48:51], v[36:37], v[92:93], v[48:51]
  ds_read_b64_tr_b16 v[32:33], v72 offset:16384
  v_mfma_f32_16x16x16_bf16 v[52:55], v[36:37], v[102:103], v[52:55]
  ds_read_b64_tr_b16 v[34:35], v72 offset:18432
  s_waitcnt lgkmcnt(6)
  v_mfma_f32_16x16x32_bf16 v[40:43], v[16:19], v[112:115], 0
  s_add_u32 m0, s88, 102400
  s_add_u32 s45, s39, 3
  s_and_b32 s45, s45, 7
  s_lshl_b32 s45, s45, 7
  s_sub_u32 s96, s45, s95
  s_mov_b32 s95, s45
  v_add_u32 v13, s96, v13
  v_add_u32 v14, s96, v14
  ds_read_b64_tr_b16 v[36:37], v72 offset:20480
  buffer_load_dwordx4 v13, s[16:19], s60 offen offset:0 lds
  v_mfma_f32_16x16x32_bf16 v[44:47], v[16:19], v[116:119], 0
  ds_read_b64_tr_b16 v[38:39], v72 offset:22528
  v_mfma_f32_16x16x32_bf16 v[40:43], v[20:23], v[120:123], v[40:43]
  s_add_u32 m0, s88, 110592
  ds_read_b64_tr_b16 v[16:17], v72 offset:24576
  buffer_load_dwordx4 v13, s[16:19], s61 offen offset:0 lds
  v_mfma_f32_16x16x32_bf16 v[44:47], v[20:23], v[124:127], v[44:47]
  v_cvt_pk_bf16_f32 v80, v48, v49
  v_cvt_pk_bf16_f32 v81, v50, v51
  ds_read_b64_tr_b16 v[18:19], v72 offset:26624
  s_waitcnt vmcnt(5)
  s_barrier
  v_add_u32 v72, 45056, v73
  s_waitcnt lgkmcnt(6)
  v_mfma_f32_16x16x32_bf16 v[40:43], v[24:27], v[128:131], v[40:43]
  s_add_u32 m0, s88, 118784
  v_cvt_pk_bf16_f32 v82, v52, v53
  v_cvt_pk_bf16_f32 v83, v54, v55
  ds_read_b64_tr_b16 v[20:21], v72 offset:0
  buffer_load_dwordx4 v13, s[16:19], s62 offen offset:0 lds
  v_mfma_f32_16x16x32_bf16 v[44:47], v[24:27], v[132:135], v[44:47]
  ds_read_b64_tr_b16 v[22:23], v72 offset:2048
  v_mfma_f32_16x16x32_bf16 v[40:43], v[28:31], v[136:139], v[40:43]
  s_add_u32 m0, s88, 126976
  s_add_u32 s44, s39, 1
  s_and_b32 s44, s44, 7
  s_lshl_b32 s44, s44, 16
  s_add_u32 s44, s44, s84
  buffer_store_dwordx4 v[80:83], v76, s[24:27], s44 offen sc1
  ds_read_b64_tr_b16 v[24:25], v72 offset:4096
  s_cbranch_vccnz L_d37
  buffer_load_dwordx4 v13, s[16:19], s63 offen offset:0 lds
L_d37:
  v_mfma_f32_16x16x32_bf16 v[44:47], v[28:31], v[140:143], v[44:47]
  ds_read_b64_tr_b16 v[26:27], v72 offset:6144
  s_waitcnt lgkmcnt(6)
  v_mfma_f32_16x16x32_bf16 v[40:43], v[32:35], v[144:147], v[40:43]
  ds_read_b64_tr_b16 v[28:29], v72 offset:8192
  v_mfma_f32_16x16x32_bf16 v[44:47], v[32:35], v[148:151], v[44:47]
  ds_read_b64_tr_b16 v[30:31], v72 offset:10240
  v_mfma_f32_16x16x32_bf16 v[40:43], v[36:39], v[152:155], v[40:43]
  ds_read_b64_tr_b16 v[32:33], v72 offset:12288
  v_mfma_f32_16x16x32_bf16 v[44:47], v[36:39], v[156:159], v[44:47]
  ds_read_b64_tr_b16 v[34:35], v72 offset:14336
  s_waitcnt lgkmcnt(6)
  v_mfma_f32_16x16x32_bf16 v[40:43], v[16:19], v[160:163], v[40:43]
  ds_read_b64_tr_b16 v[36:37], v72 offset:16384
  v_mfma_f32_16x16x32_bf16 v[44:47], v[16:19], v[164:167], v[44:47]
  ds_read_b64_tr_b16 v[38:39], v72 offset:18432
  v_mfma_f32_16x16x32_bf16 v[40:43], v[20:23], v[168:171], v[40:43]
  s_add_u32 m0, s88, 131072
  ds_read_b64_tr_b16 v[16:17], v72 offset:20480
  buffer_load_dwordx4 v13, s[16:19], s41 offen offset:0 lds
  v_mfma_f32_16x16x32_bf16 v[44:47], v[20:23], v[172:175], v[44:47]
  ds_read_b64_tr_b16 v[18:19], v72 offset:22528
  s_waitcnt lgkmcnt(6)
  v_mfma_f32_16x16x32_bf16 v[40:43], v[24:27], v[176:179], v[40:43]
  s_add_u32 m0, s88, 139264
  ds_read_b64_tr_b16 v[20:21], v72 offset:24576
  buffer_load_dwordx4 v13, s[16:19], s42 offen offset:0 lds
  v_mfma_f32_16x16x32_bf16 v[44:47], v[24:27], v[180:183], v[44:47]
  ds_read_b64_tr_b16 v[22:23], v72 offset:26624
  s_waitcnt vmcnt(6)
  s_barrier
  v_add_u32 v72, 73728, v73
  v_add_u32 v74, 73728, v75
  v_mfma_f32_16x16x32_bf16 v[40:43], v[28:31], v[184:187], v[40:43]
  s_add_u32 m0, s88, 147456
  ds_read_b64_tr_b16 v[24:25], v72 offset:0
  buffer_load_dwordx4 v13, s[16:19], s43 offen offset:0 lds
  v_mfma_f32_16x16x32_bf16 v[44:47], v[28:31], v[188:191], v[44:47]
  ds_read_b64_tr_b16 v[26:27], v72 offset:2048
  s_waitcnt lgkmcnt(6)
  v_mfma_f32_16x16x32_bf16 v[40:43], v[32:35], v[192:195], v[40:43]
  s_add_u32 m0, s88, 155648
  ds_read_b64_tr_b16 v[28:29], v72 offset:4096
  s_cbranch_vccnz L_d38
  buffer_load_dwordx4 v13, s[16:19], s65 offen offset:0 lds
L_d38:
  v_mfma_f32_16x16x32_bf16 v[44:47], v[32:35], v[196:199], v[44:47]
  ds_read_b64_tr_b16 v[30:31], v72 offset:6144
  v_mfma_f32_16x16x32_bf16 v[40:43], v[36:39], v[200:203], v[40:43]
  ds_read_b64_tr_b16 v[32:33], v72 offset:8192
  v_mfma_f32_16x16x32_bf16 v[44:47], v[36:39], v[204:207], v[44:47]
  ds_read_b64_tr_b16 v[34:35], v72 offset:10240
  s_waitcnt lgkmcnt(6)
  v_mfma_f32_16x16x32_bf16 v[40:43], v[16:19], v[208:211], v[40:43]
  ds_read_b64_tr_b16 v[36:37], v72 offset:12288
  v_mfma_f32_16x16x32_bf16 v[44:47], v[16:19], v[212:215], v[44:47]
  ds_read_b64_tr_b16 v[38:39], v72 offset:14336
  v_mfma_f32_16x16x32_bf16 v[40:43], v[20:23], v[216:219], v[40:43]
  ds_read_b64_tr_b16 v[16:17], v72 offset:16384
  v_mfma_f32_16x16x32_bf16 v[44:47], v[20:23], v[220:223], v[44:47]
  ds_read_b64_tr_b16 v[18:19], v72 offset:18432
  s_waitcnt lgkmcnt(6)
  v_mfma_f32_16x16x32_bf16 v[40:43], v[24:27], v[224:227], v[40:43]
  s_add_u32 m0, s88, 16384
  ds_read_b64_tr_b16 v[20:21], v72 offset:20480
  buffer_load_dwordx4 v13, s[16:19], s85 offen offset:0 lds
  v_mfma_f32_16x16x32_bf16 v[44:47], v[24:27], v[228:231], v[44:47]
  ds_read_b64_tr_b16 v[22:23], v72 offset:22528
  v_mfma_f32_16x16x32_bf16 v[40:43], v[28:31], v[232:235], v[40:43]
  s_add_u32 m0, s88, 24576
  ds_read_b64_tr_b16 v[24:25], v74 offset:24576
  buffer_load_dwordx4 v13, s[16:19], s89 offen offset:0 lds
  v_mfma_f32_16x16x32_bf16 v[44:47], v[28:31], v[236:239], v[44:47]
  s_waitcnt vmcnt(6)
  s_barrier
  v_add_u32 v72, 102400, v73
  s_waitcnt lgkmcnt(5)
  v_mfma_f32_16x16x32_bf16 v[40:43], v[32:35], v[240:243], v[40:43]
  s_add_u32 m0, s88, 32768
  ds_read_b64_tr_b16 v[28:29], v72 offset:0
  buffer_load_dwordx4 v14, s[20:23], 0 offen offset:0 lds
  v_mfma_f32_16x16x32_bf16 v[44:47], v[32:35], v[244:247], v[44:47]
  ds_read_b64_tr_b16 v[30:31], v72 offset:2048
  v_mfma_f32_16x16x32_bf16 v[40:43], v[36:39], v[248:251], v[40:43]
  s_add_u32 m0, s88, 40960
  ds_read_b64_tr_b16 v[32:33], v72 offset:4096
  s_cmp_ge_u32 s36, 1
  s_cbranch_scc1 L_d39
  buffer_load_dwordx4 v14, s[20:23], s61 offen offset:0 lds
L_d39:
  v_mfma_f32_16x16x32_bf16 v[44:47], v[36:39], v[252:255], v[44:47]
  ds_read_b64_tr_b16 v[34:35], v72 offset:6144
  s_waitcnt lgkmcnt(5)
  v_mfma_f32_16x16x32_bf16 v[40:43], v[16:19], v[84:87], v[40:43]
  ds_read_b64_tr_b16 v[36:37], v72 offset:8192
  v_mfma_f32_16x16x32_bf16 v[44:47], v[16:19], v[94:97], v[44:47]
  ds_read_b64_tr_b16 v[38:39], v72 offset:10240
  v_mfma_f32_16x16x32_bf16 v[40:43], v[20:23], v[88:91], v[40:43]
  ds_read_b64_tr_b16 v[16:17], v72 offset:12288
  v_mfma_f32_16x16x32_bf16 v[44:47], v[20:23], v[98:101], v[44:47]
  ds_read_b64_tr_b16 v[18:19], v72 offset:14336
  s_waitcnt lgkmcnt(6)
  v_mfma_f32_16x16x16_bf16 v[40:43], v[24:25], v[92:93], v[40:43]
  ds_read_b64_tr_b16 v[20:21], v72 offset:16384
  v_mfma_f32_16x16x16_bf16 v[44:47], v[24:25], v[102:103], v[44:47]
  ds_read_b64_tr_b16 v[22:23], v72 offset:18432
  v_mfma_f32_16x16x32_bf16 v[48:51], v[28:31], v[112:115], 0
  s_add_u32 m0, s88, 45056
  s_add_u32 s45, s39, 4
  s_and_b32 s45, s45, 7
  s_lshl_b32 s45, s45, 7
  s_sub_u32 s96, s45, s95
  s_mov_b32 s95, s45
  v_add_u32 v13, s96, v13
  v_add_u32 v14, s96, v14
  ds_read_b64_tr_b16 v[24:25], v72 offset:20480
  buffer_load_dwordx4 v13, s[16:19], s60 offen offset:0 lds
  v_mfma_f32_16x16x32_bf16 v[52:55], v[28:31], v[116:119], 0
  ds_read_b64_tr_b16 v[26:27], v72 offset:22528
  s_waitcnt lgkmcnt(6)
  v_mfma_f32_16x16x32_bf16 v[48:51], v[32:35], v[120:123], v[48:51]
  s_add_u32 m0, s88, 53248
  ds_read_b64_tr_b16 v[28:29], v72 offset:24576
  buffer_load_dwordx4 v13, s[16:19], s61 offen offset:0 lds
  v_mfma_f32_16x16x32_bf16 v[52:55], v[32:35], v[124:127], v[52:55]
  v_cvt_pk_bf16_f32 v80, v40, v41
  v_cvt_pk_bf16_f32 v81, v42, v43
  ds_read_b64_tr_b16 v[30:31], v72 offset:26624
  s_waitcnt vmcnt(5)
  s_barrier
  v_add_u32 v72, 131072, v73
  v_mfma_f32_16x16x32_bf16 v[48:51], v[36:39], v[128:131], v[48:51]
  s_add_u32 m0, s88, 61440
  v_cvt_pk_bf16_f32 v82, v44, v45
  v_cvt_pk_bf16_f32 v83, v46, v47
  ds_read_b64_tr_b16 v[32:33], v72 offset:0
  buffer_load_dwordx4 v13, s[16:19], s62 offen offset:0 lds
  v_mfma_f32_16x16x32_bf16 v[52:55], v[36:39], v[132:135], v[52:55]
  ds_read_b64_tr_b16 v[34:35], v72 offset:2048
  s_waitcnt lgkmcnt(6)
  v_mfma_f32_16x16x32_bf16 v[48:51], v[16:19], v[136:139], v[48:51]
  s_add_u32 m0, s88, 69632
  s_add_u32 s44, s39, 2
  s_and_b32 s44, s44, 7
  s_lshl_b32 s44, s44, 16
  s_add_u32 s44, s44, s84
  buffer_store_dwordx4 v[80:83], v76, s[24:27], s44 offen sc1
  ds_read_b64_tr_b16 v[36:37], v72 offset:4096
  s_cbranch_vccnz L_d40
  buffer_load_dwordx4 v13, s[16:19], s63 offen offset:0 lds
L_d40:
  v_mfma_f32_16x16x32_bf16 v[52:55], v[16:19], v[140:143], v[52:55]
  ds_read_b64_tr_b16 v[38:39], v72 offset:6144
  v_mfma_f32_16x16x32_bf16 v[48:51], v[20:23], v[144:147], v[48:51]
  ds_read_b64_tr_b16 v[16:17], v72 offset:8192
  v_mfma_f32_16x16x32_bf16 v[52:55], v[20:23], v[148:151], v[52:55]
  ds_read_b64_tr_b16 v[18:19], v72 offset:10240
  s_waitcnt lgkmcnt(6)
  v_mfma_f32_16x16x32_bf16 v[48:51], v[24:27], v[152:155], v[48:51]
  ds_read_b64_tr_b16 v[20:21], v72 offset:12288
  v_mfma_f32_16x16x32_bf16 v[52:55], v[24:27], v[156:159], v[52:55]
  ds_read_b64_tr_b16 v[22:23], v72 offset:14336
  v_mfma_f32_16x16x32_bf16 v[48:51], v[28:31], v[160:163], v[48:51]
  ds_read_b64_tr_b16 v[24:25], v72 offset:16384
  v_mfma_f32_16x16x32_bf16 v[52:55], v[28:31], v[164:167], v[52:55]
  ds_read_b64_tr_b16 v[26:27], v72 offset:18432
  s_waitcnt lgkmcnt(6)
  v_mfma_f32_16x16x32_bf16 v[48:51], v[32:35], v[168:171], v[48:51]
  s_add_u32 m0, s88, 73728
  ds_read_b64_tr_b16 v[28:29], v72 offset:20480
  buffer_load_dwordx4 v13, s[16:19], s41 offen offset:0 lds
  v_mfma_f32_16x16x32_bf16 v[52:55], v[32:35], v[172:175], v[52:55]
  ds_read_b64_tr_b16 v[30:31], v72 offset:22528
  v_mfma_f32_16x16x32_bf16 v[48:51], v[36:39], v[176:179], v[48:51]
  s_add_u32 m0, s88, 81920
  ds_read_b64_tr_b16 v[32:33], v72 offset:24576
  buffer_load_dwordx4 v13, s[16:19], s42 offen offset:0 lds
  v_mfma_f32_16x16x32_bf16 v[52:55], v[36:39], v[180:183], v[52:55]
  ds_read_b64_tr_b16 v[34:35], v72 offset:26624
  s_waitcnt vmcnt(6)
  s_barrier
  v_add_u32 v72, 16384, v73
  v_add_u32 v74, 16384, v75
  s_waitcnt lgkmcnt(6)
  v_mfma_f32_16x16x32_bf16 v[48:51], v[16:19], v[184:187], v[48:51]
  s_add_u32 m0, s88, 90112
  ds_read_b64_tr_b16 v[36:37], v72 offset:0
  buffer_load_dwordx4 v13, s[16:19], s43 offen offset:0 lds
  v_mfma_f32_16x16x32_bf16 v[52:55], v[16:19], v[188:191], v[52:55]
  ds_read_b64_tr_b16 v[38:39], v72 offset:2048
  v_mfma_f32_16x16x32_bf16 v[48:51], v[20:23], v[192:195], v[48:51]
  s_add_u32 m0, s88, 98304
  ds_read_b64_tr_b16 v[16:17], v72 offset:4096
  s_cbranch_vccnz L_d41
  buffer_load_dwordx4 v13, s[16:19], s65 offen offset:0 lds
L_d41:
  v_mfma_f32_16x16x32_bf16 v[52:55], v[20:23], v[196:199], v[52:55]
  ds_read_b64_tr_b16 v[18:19], v72 offset:6144
  s_waitcnt lgkmcnt(6)
  v_mfma_f32_16x16x32_bf16 v[48:51], v[24:27], v[200:203], v[48:51]
  ds_read_b64_tr_b16 v[20:21], v72 offset:8192
  v_mfma_f32_16x16x32_bf16 v[52:55], v[24:27], v[204:207], v[52:55]
  ds_read_b64_tr_b16 v[22:23], v72 offset:10240
  v_mfma_f32_16x16x32_bf16 v[48:51], v[28:31], v[208:211], v[48:51]
  ds_read_b64_tr_b16 v[24:25], v72 offset:12288
  v_mfma_f32_16x16x32_bf16 v[52:55], v[28:31], v[212:215], v[52:55]
  ds_read_b64_tr_b16 v[26:27], v72 offset:14336
  s_waitcnt lgkmcnt(6)
  v_mfma_f32_16x16x32_bf16 v[48:51], v[32:35], v[216:219], v[48:51]
  ds_read_b64_tr_b16 v[28:29], v72 offset:16384
  v_mfma_f32_16x16x32_bf16 v[52:55], v[32:35], v[220:223], v[52:55]
  ds_read_b64_tr_b16 v[30:31], v72 offset:18432
  v_mfma_f32_16x16x32_bf16 v[48:51], v[36:39], v[224:227], v[48:51]
  s_add_u32 m0, s88, 102400
  ds_read_b64_tr_b16 v[32:33], v72 offset:20480
  buffer_load_dwordx4 v13, s[16:19], s85 offen offset:0 lds
  v_mfma_f32_16x16x32_bf16 v[52:55], v[36:39], v[228:231], v[52:55]
  ds_read_b64_tr_b16 v[34:35], v72 offset:22528
  s_waitcnt lgkmcnt(6)
  v_mfma_f32_16x16x32_bf16 v[48:51], v[16:19], v[232:235], v[48:51]
  s_add_u32 m0, s88, 110592
  ds_read_b64_tr_b16 v[36:37], v74 offset:24576
  buffer_load_dwordx4 v13, s[16:19], s89 offen offset:0 lds
  v_mfma_f32_16x16x32_bf16 v[52:55], v[16:19], v[236:239], v[52:55]
  s_waitcnt vmcnt(6)
  s_barrier
  v_add_u32 v72, 45056, v73
  v_mfma_f32_16x16x32_bf16 v[48:51], v[20:23], v[240:243], v[48:51]
  s_add_u32 m0, s88, 118784
  ds_read_b64_tr_b16 v[16:17], v72 offset:0
  buffer_load_dwordx4 v14, s[20:23], 0 offen offset:0 lds
  v_mfma_f32_16x16x32_bf16 v[52:55], v[20:23], v[244:247], v[52:55]
  ds_read_b64_tr_b16 v[18:19], v72 offset:2048
  s_waitcnt lgkmcnt(5)
  v_mfma_f32_16x16x32_bf16 v[48:51], v[24:27], v[248:251], v[48:51]
  s_add_u32 m0, s88, 126976
  ds_read_b64_tr_b16 v[20:21], v72 offset:4096
  s_cmp_ge_u32 s36, 1
  s_cbranch_scc1 L_d42
  buffer_load_dwordx4 v14, s[20:23], s61 offen offset:0 lds
L_d42:
  v_mfma_f32_16x16x32_bf16 v[52:55], v[24:27], v[252:255], v[52:55]
  ds_read_b64_tr_b16 v[22:23], v72 offset:6144
  v_mfma_f32_16x16x32_bf16 v[48:51], v[28:31], v[84:87], v[48:51]
  ds_read_b64_tr_b16 v[24:25], v72 offset:8192
  v_mfma_f32_16x16x32_bf16 v[52:55], v[28:31], v[94:97], v[52:55]
  ds_read_b64_tr_b16 v[26:27], v72 offset:10240
  s_waitcnt lgkmcnt(6)
  v_mfma_f32_16x16x32_bf16 v[48:51], v[32:35], v[88:91], v[48:51]
  ds_read_b64_tr_b16 v[28:29], v72 offset:12288
  v_mfma_f32_16x16x32_bf16 v[52:55], v[32:35], v[98:101], v[52:55]
  ds_read_b64_tr_b16 v[30:31], v72 offset:14336
  v_mfma_f32_16x16x16_bf16 v[48:51], v[36:37], v[92:93], v[48:51]
  ds_read_b64_tr_b16 v[32:33], v72 offset:16384
  v_mfma_f32_16x16x16_bf16 v[52:55], v[36:37], v[102:103], v[52:55]
  ds_read_b64_tr_b16 v[34:35], v72 offset:18432
  s_waitcnt lgkmcnt(6)
  v_mfma_f32_16x16x32_bf16 v[40:43], v[16:19], v[112:115], 0
  s_add_u32 m0, s88, 131072
  s_add_u32 s45, s39, 5
  s_and_b32 s45, s45, 7
  s_lshl_b32 s45, s45, 7
  s_sub_u32 s96, s45, s95
  s_mov_b32 s95, s45
  v_add_u32 v13, s96, v13
  v_add_u32 v14, s96, v14
  ds_read_b64_tr_b16 v[36:37], v72 offset:20480
  buffer_load_dwordx4 v13, s[16:19], s60 offen offset:0 lds
  v_mfma_f32_16x16x32_bf16 v[44:47], v[16:19], v[116:119], 0
  ds_read_b64_tr_b16 v[38:39], v72 offset:22528
  v_mfma_f32_16x16x32_bf16 v[40:43], v[20:23], v[120:123], v[40:43]
  s_add_u32 m0, s88, 139264
  ds_read_b64_tr_b16 v[16:17], v72 offset:24576
  buffer_load_dwordx4 v13, s[16:19], s61 offen offset:0 lds
  v_mfma_f32_16x16x32_bf16 v[44:47], v[20:23], v[124:127], v[44:47]
  v_cvt_pk_bf16_f32 v80, v48, v49
  v_cvt_pk_bf16_f32 v81, v50, v51
  ds_read_b64_tr_b16 v[18:19], v72 offset:26624
  s_waitcnt vmcnt(5)
  s_barrier
  v_add_u32 v72, 73728, v73
  s_waitcnt lgkmcnt(6)
  v_mfma_f32_16x16x32_bf16 v[40:43], v[24:27], v[128:131], v[40:43]
  s_add_u32 m0, s88, 147456
  v_cvt_pk_bf16_f32 v82, v52, v53
  v_cvt_pk_bf16_f32 v83, v54, v55
  ds_read_b64_tr_b16 v[20:21], v72 offset:0
  buffer_load_dwordx4 v13, s[16:19], s62 offen offset:0 lds
  v_mfma_f32_16x16x32_bf16 v[44:47], v[24:27], v[132:135], v[44:47]
  ds_read_b64_tr_b16 v[22:23], v72 offset:2048
  v_mfma_f32_16x16x32_bf16 v[40:43], v[28:31], v[136:139], v[40:43]
  s_add_u32 m0, s88, 155648
  s_add_u32 s44, s39, 3
  s_and_b32 s44, s44, 7
  s_lshl_b32 s44, s44, 16
  s_add_u32 s44, s44, s84
  buffer_store_dwordx4 v[80:83], v76, s[24:27], s44 offen sc1
  ds_read_b64_tr_b16 v[24:25], v72 offset:4096
  s_cbranch_vccnz L_d43
  buffer_load_dwordx4 v13, s[16:19], s63 offen offset:0 lds
L_d43:
  v_mfma_f32_16x16x32_bf16 v[44:47], v[28:31], v[140:143], v[44:47]
  ds_read_b64_tr_b16 v[26:27], v72 offset:6144
  s_waitcnt lgkmcnt(6)
  v_mfma_f32_16x16x32_bf16 v[40:43], v[32:35], v[144:147], v[40:43]
  ds_read_b64_tr_b16 v[28:29], v72 offset:8192
  v_mfma_f32_16x16x32_bf16 v[44:47], v[32:35], v[148:151], v[44:47]
  ds_read_b64_tr_b16 v[30:31], v72 offset:10240
  v_mfma_f32_16x16x32_bf16 v[40:43], v[36:39], v[152:155], v[40:43]
  ds_read_b64_tr_b16 v[32:33], v72 offset:12288
  v_mfma_f32_16x16x32_bf16 v[44:47], v[36:39], v[156:159], v[44:47]
  ds_read_b64_tr_b16 v[34:35], v72 offset:14336
  s_waitcnt lgkmcnt(6)
  v_mfma_f32_16x16x32_bf16 v[40:43], v[16:19], v[160:163], v[40:43]
  ds_read_b64_tr_b16 v[36:37], v72 offset:16384
  v_mfma_f32_16x16x32_bf16 v[44:47], v[16:19], v[164:167], v[44:47]
  ds_read_b64_tr_b16 v[38:39], v72 offset:18432
  v_mfma_f32_16x16x32_bf16 v[40:43], v[20:23], v[168:171], v[40:43]
  s_add_u32 m0, s88, 16384
  ds_read_b64_tr_b16 v[16:17], v72 offset:20480
  buffer_load_dwordx4 v13, s[16:19], s41 offen offset:0 lds
  v_mfma_f32_16x16x32_bf16 v[44:47], v[20:23], v[172:175], v[44:47]
  ds_read_b64_tr_b16 v[18:19], v72 offset:22528
  s_waitcnt lgkmcnt(6)
  v_mfma_f32_16x16x32_bf16 v[40:43], v[24:27], v[176:179], v[40:43]
  s_add_u32 m0, s88, 24576
  ds_read_b64_tr_b16 v[20:21], v72 offset:24576
  buffer_load_dwordx4 v13, s[16:19], s42 offen offset:0 lds
  v_mfma_f32_16x16x32_bf16 v[44:47], v[24:27], v[180:183], v[44:47]
  ds_read_b64_tr_b16 v[22:23], v72 offset:26624
  s_waitcnt vmcnt(6)
  s_barrier
  v_add_u32 v72, 102400, v73
  v_add_u32 v74, 102400, v75
  v_mfma_f32_16x16x32_bf16 v[40:43], v[28:31], v[184:187], v[40:43]
  s_add_u32 m0, s88, 32768
  ds_read_b64_tr_b16 v[24:25], v72 offset:0
  buffer_load_dwordx4 v13, s[16:19], s43 offen offset:0 lds
  v_mfma_f32_16x16x32_bf16 v[44:47], v[28:31], v[188:191], v[44:47]
  ds_read_b64_tr_b16 v[26:27], v72 offset:2048
  s_waitcnt lgkmcnt(6)
  v_mfma_f32_16x16x32_bf16 v[40:43], v[32:35], v[192:195], v[40:43]
  s_add_u32 m0, s88, 40960
  ds_read_b64_tr_b16 v[28:29], v72 offset:4096
  s_cbranch_vccnz L_d44
  buffer_load_dwordx4 v13, s[16:19], s65 offen offset:0 lds
L_d44:
  v_mfma_f32_16x16x32_bf16 v[44:47], v[32:35], v[196:199], v[44:47]
  ds_read_b64_tr_b16 v[30:31], v72 offset:6144
  v_mfma_f32_16x16x32_bf16 v[40:43], v[36:39], v[200:203], v[40:43]
  ds_read_b64_tr_b16 v[32:33], v72 offset:8192
  v_mfma_f32_16x16x32_bf16 v[44:47], v[36:39], v[204:207], v[44:47]
  ds_read_b64_tr_b16 v[34:35], v72 offset:10240
  s_waitcnt lgkmcnt(6)
  v_mfma_f32_16x16x32_bf16 v[40:43], v[16:19], v[208:211], v[40:43]
  ds_read_b64_tr_b16 v[36:37], v72 offset:12288
  v_mfma_f32_16x16x32_bf16 v[44:47], v[16:19], v[212:215], v[44:47]
  ds_read_b64_tr_b16 v[38:39], v72 offset:14336
  v_mfma_f32_16x16x32_bf16 v[40:43], v[20:23], v[216:219], v[40:43]
  ds_read_b64_tr_b16 v[16:17], v72 offset:16384
  v_mfma_f32_16x16x32_bf16 v[44:47], v[20:23], v[220:223], v[44:47]
  ds_read_b64_tr_b16 v[18:19], v72 offset:18432
  s_waitcnt lgkmcnt(6)
  v_mfma_f32_16x16x32_bf16 v[40:43], v[24:27], v[224:227], v[40:43]
  s_add_u32 m0, s88, 45056
  ds_read_b64_tr_b16 v[20:21], v72 offset:20480
  buffer_load_dwordx4 v13, s[16:19], s85 offen offset:0 lds
  v_mfma_f32_16x16x32_bf16 v[44:47], v[24:27], v[228:231], v[44:47]
  ds_read_b64_tr_b16 v[22:23], v72 offset:22528
  v_mfma_f32_16x16x32_bf16 v[40:43], v[28:31], v[232:235], v[40:43]
  s_add_u32 m0, s88, 53248
  ds_read_b64_tr_b16 v[24:25], v74 offset:24576
  buffer_load_dwordx4 v13, s[16:19], s89 offen offset:0 lds
  v_mfma_f32_16x16x32_bf16 v[44:47], v[28:31], v[236:239], v[44:47]
  s_waitcnt vmcnt(6)
  s_barrier
  v_add_u32 v72, 131072, v73
  s_waitcnt lgkmcnt(5)
  v_mfma_f32_16x16x32_bf16 v[40:43], v[32:35], v[240:243], v[40:43]
  s_add_u32 m0, s88, 61440
  ds_read_b64_tr_b16 v[28:29], v72 offset:0
  buffer_load_dwordx4 v14, s[20:23], 0 offen offset:0 lds
  v_mfma_f32_16x16x32_bf16 v[44:47], v[32:35], v[244:247], v[44:47]
  ds_read_b64_tr_b16 v[30:31], v72 offset:2048
  v_mfma_f32_16x16x32_bf16 v[40:43], v[36:39], v[248:251], v[40:43]
  s_add_u32 m0, s88, 69632
  ds_read_b64_tr_b16 v[32:33], v72 offset:4096
  s_cmp_ge_u32 s36, 1
  s_cbranch_scc1 L_d45
  buffer_load_dwordx4 v14, s[20:23], s61 offen offset:0 lds
L_d45:
  v_mfma_f32_16x16x32_bf16 v[44:47], v[36:39], v[252:255], v[44:47]
  ds_read_b64_tr_b16 v[34:35], v72 offset:6144
  s_waitcnt lgkmcnt(5)
  v_mfma_f32_16x16x32_bf16 v[40:43], v[16:19], v[84:87], v[40:43]
  ds_read_b64_tr_b16 v[36:37], v72 offset:8192
  v_mfma_f32_16x16x32_bf16 v[44:47], v[16:19], v[94:97], v[44:47]
  ds_read_b64_tr_b16 v[38:39], v72 offset:10240
  v_mfma_f32_16x16x32_bf16 v[40:43], v[20:23], v[88:91], v[40:43]
  ds_read_b64_tr_b16 v[16:17], v72 offset:12288
  v_mfma_f32_16x16x32_bf16 v[44:47], v[20:23], v[98:101], v[44:47]
  ds_read_b64_tr_b16 v[18:19], v72 offset:14336
  s_waitcnt lgkmcnt(6)
  v_mfma_f32_16x16x16_bf16 v[40:43], v[24:25], v[92:93], v[40:43]
  ds_read_b64_tr_b16 v[20:21], v72 offset:16384
  v_mfma_f32_16x16x16_bf16 v[44:47], v[24:25], v[102:103], v[44:47]
  ds_read_b64_tr_b16 v[22:23], v72 offset:18432
  v_mfma_f32_16x16x32_bf16 v[48:51], v[28:31], v[112:115], 0
  s_add_u32 m0, s88, 73728
  s_add_u32 s45, s39, 6
  s_and_b32 s45, s45, 7
  s_lshl_b32 s45, s45, 7
  s_sub_u32 s96, s45, s95
  s_mov_b32 s95, s45
  v_add_u32 v13, s96, v13
  v_add_u32 v14, s96, v14
  ds_read_b64_tr_b16 v[24:25], v72 offset:20480
  buffer_load_dwordx4 v13, s[16:19], s60 offen offset:0 lds
  v_mfma_f32_16x16x32_bf16 v[52:55], v[28:31], v[116:119], 0
  ds_read_b64_tr_b16 v[26:27], v72 offset:22528
  s_waitcnt lgkmcnt(6)
  v_mfma_f32_16x16x32_bf16 v[48:51], v[32:35], v[120:123], v[48:51]
  s_add_u32 m0, s88, 81920
  ds_read_b64_tr_b16 v[28:29], v72 offset:24576
  buffer_load_dwordx4 v13, s[16:19], s61 offen offset:0 lds
  v_mfma_f32_16x16x32_bf16 v[52:55], v[32:35], v[124:127], v[52:55]
  v_cvt_pk_bf16_f32 v80, v40, v41
  v_cvt_pk_bf16_f32 v81, v42, v43
  ds_read_b64_tr_b16 v[30:31], v72 offset:26624
  s_waitcnt vmcnt(5)
  s_barrier
  v_add_u32 v72, 16384, v73
  v_mfma_f32_16x16x32_bf16 v[48:51], v[36:39], v[128:131], v[48:51]
  s_add_u32 m0, s88, 90112
  v_cvt_pk_bf16_f32 v82, v44, v45
  v_cvt_pk_bf16_f32 v83, v46, v47
  ds_read_b64_tr_b16 v[32:33], v72 offset:0
  buffer_load_dwordx4 v13, s[16:19], s62 offen offset:0 lds
  v_mfma_f32_16x16x32_bf16 v[52:55], v[36:39], v[132:135], v[52:55]
  ds_read_b64_tr_b16 v[34:35], v72 offset:2048
  s_waitcnt lgkmcnt(6)
  v_mfma_f32_16x16x32_bf16 v[48:51], v[16:19], v[136:139], v[48:51]
  s_add_u32 m0, s88, 98304
  s_add_u32 s44, s39, 4
  s_and_b32 s44, s44, 7
  s_lshl_b32 s44, s44, 16
  s_add_u32 s44, s44, s84
  buffer_store_dwordx4 v[80:83], v76, s[24:27], s44 offen sc1
  ds_read_b64_tr_b16 v[36:37], v72 offset:4096
  s_cbranch_vccnz L_d46
  buffer_load_dwordx4 v13, s[16:19], s63 offen offset:0 lds
L_d46:
  v_mfma_f32_16x16x32_bf16 v[52:55], v[16:19], v[140:143], v[52:55]
  ds_read_b64_tr_b16 v[38:39], v72 offset:6144
  v_mfma_f32_16x16x32_bf16 v[48:51], v[20:23], v[144:147], v[48:51]
  ds_read_b64_tr_b16 v[16:17], v72 offset:8192
  v_mfma_f32_16x16x32_bf16 v[52:55], v[20:23], v[148:151], v[52:55]
  ds_read_b64_tr_b16 v[18:19], v72 offset:10240
  s_waitcnt lgkmcnt(6)
  v_mfma_f32_16x16x32_bf16 v[48:51], v[24:27], v[152:155], v[48:51]
  ds_read_b64_tr_b16 v[20:21], v72 offset:12288
  v_mfma_f32_16x16x32_bf16 v[52:55], v[24:27], v[156:159], v[52:55]
  ds_read_b64_tr_b16 v[22:23], v72 offset:14336
  v_mfma_f32_16x16x32_bf16 v[48:51], v[28:31], v[160:163], v[48:51]
  ds_read_b64_tr_b16 v[24:25], v72 offset:16384
  v_mfma_f32_16x16x32_bf16 v[52:55], v[28:31], v[164:167], v[52:55]
  ds_read_b64_tr_b16 v[26:27], v72 offset:18432
  s_waitcnt lgkmcnt(6)
  v_mfma_f32_16x16x32_bf16 v[48:51], v[32:35], v[168:171], v[48:51]
  s_add_u32 m0, s88, 102400
  ds_read_b64_tr_b16 v[28:29], v72 offset:20480
  buffer_load_dwordx4 v13, s[16:19], s41 offen offset:0 lds
  v_mfma_f32_16x16x32_bf16 v[52:55], v[32:35], v[172:175], v[52:55]
  ds_read_b64_tr_b16 v[30:31], v72 offset:22528
  v_mfma_f32_16x16x32_bf16 v[48:51], v[36:39], v[176:179], v[48:51]
  s_add_u32 m0, s88, 110592
  ds_read_b64_tr_b16 v[32:33], v72 offset:24576
  buffer_load_dwordx4 v13, s[16:19], s42 offen offset:0 lds
  v_mfma_f32_16x16x32_bf16 v[52:55], v[36:39], v[180:183], v[52:55]
  ds_read_b64_tr_b16 v[34:35], v72 offset:26624
  s_waitcnt vmcnt(6)
  s_barrier
  v_add_u32 v72, 45056, v73
  v_add_u32 v74, 45056, v75
  s_waitcnt lgkmcnt(6)
  v_mfma_f32_16x16x32_bf16 v[48:51], v[16:19], v[184:187], v[48:51]
  s_add_u32 m0, s88, 118784
  ds_read_b64_tr_b16 v[36:37], v72 offset:0
  buffer_load_dwordx4 v13, s[16:19], s43 offen offset:0 lds
  v_mfma_f32_16x16x32_bf16 v[52:55], v[16:19], v[188:191], v[52:55]
  ds_read_b64_tr_b16 v[38:39], v72 offset:2048
  v_mfma_f32_16x16x32_bf16 v[48:51], v[20:23], v[192:195], v[48:51]
  s_add_u32 m0, s88, 126976
  ds_read_b64_tr_b16 v[16:17], v72 offset:4096
  s_cbranch_vccnz L_d47
  buffer_load_dwordx4 v13, s[16:19], s65 offen offset:0 lds
L_d47:
  v_mfma_f32_16x16x32_bf16 v[52:55], v[20:23], v[196:199], v[52:55]
  ds_read_b64_tr_b16 v[18:19], v72 offset:6144
  s_waitcnt lgkmcnt(6)
  v_mfma_f32_16x16x32_bf16 v[48:51], v[24:27], v[200:203], v[48:51]
  ds_read_b64_tr_b16 v[20:21], v72 offset:8192
  v_mfma_f32_16x16x32_bf16 v[52:55], v[24:27], v[204:207], v[52:55]
  ds_read_b64_tr_b16 v[22:23], v72 offset:10240
  v_mfma_f32_16x16x32_bf16 v[48:51], v[28:31], v[208:211], v[48:51]
  ds_read_b64_tr_b16 v[24:25], v72 offset:12288
  v_mfma_f32_16x16x32_bf16 v[52:55], v[28:31], v[212:215], v[52:55]
  ds_read_b64_tr_b16 v[26:27], v72 offset:14336
  s_waitcnt lgkmcnt(6)
  v_mfma_f32_16x16x32_bf16 v[48:51], v[32:35], v[216:219], v[48:51]
  ds_read_b64_tr_b16 v[28:29], v72 offset:16384
  v_mfma_f32_16x16x32_bf16 v[52:55], v[32:35], v[220:223], v[52:55]
  ds_read_b64_tr_b16 v[30:31], v72 offset:18432
  v_mfma_f32_16x16x32_bf16 v[48:51], v[36:39], v[224:227], v[48:51]
  s_add_u32 m0, s88, 131072
  ds_read_b64_tr_b16 v[32:33], v72 offset:20480
  buffer_load_dwordx4 v13, s[16:19], s85 offen offset:0 lds
  v_mfma_f32_16x16x32_bf16 v[52:55], v[36:39], v[228:231], v[52:55]
  ds_read_b64_tr_b16 v[34:35], v72 offset:22528
  s_waitcnt lgkmcnt(6)
  v_mfma_f32_16x16x32_bf16 v[48:51], v[16:19], v[232:235], v[48:51]
  s_add_u32 m0, s88, 139264
  ds_read_b64_tr_b16 v[36:37], v74 offset:24576
  buffer_load_dwordx4 v13, s[16:19], s89 offen offset:0 lds
  v_mfma_f32_16x16x32_bf16 v[52:55], v[16:19], v[236:239], v[52:55]
  s_waitcnt vmcnt(6)
  s_barrier
  v_add_u32 v72, 73728, v73
  v_and_b32 v104, 7, v0
  v_lshlrev_b32 v104, 5, v104
  s_and_b32 s44, s40, 28
  v_add_u32 v104, s44, v104
  global_load_dword v104, v104, s[28:29] sc0 sc1
  v_mfma_f32_16x16x32_bf16 v[48:51], v[20:23], v[240:243], v[48:51]
  s_add_u32 m0, s88, 147456
  ds_read_b64_tr_b16 v[16:17], v72 offset:0
  buffer_load_dwordx4 v14, s[20:23], 0 offen offset:0 lds
  v_mfma_f32_16x16x32_bf16 v[52:55], v[20:23], v[244:247], v[52:55]
  ds_read_b64_tr_b16 v[18:19], v72 offset:2048
  s_waitcnt lgkmcnt(5)
  v_mfma_f32_16x16x32_bf16 v[48:51], v[24:27], v[248:251], v[48:51]
  s_add_u32 m0, s88, 155648
  ds_read_b64_tr_b16 v[20:21], v72 offset:4096
  s_cmp_ge_u32 s36, 1
  s_cbranch_scc1 L_d48
  buffer_load_dwordx4 v14, s[20:23], s61 offen offset:0 lds
L_d48:
  v_mfma_f32_16x16x32_bf16 v[52:55], v[24:27], v[252:255], v[52:55]
  ds_read_b64_tr_b16 v[22:23], v72 offset:6144
  v_mfma_f32_16x16x32_bf16 v[48:51], v[28:31], v[84:87], v[48:51]
  ds_read_b64_tr_b16 v[24:25], v72 offset:8192
  v_mfma_f32_16x16x32_bf16 v[52:55], v[28:31], v[94:97], v[52:55]
  ds_read_b64_tr_b16 v[26:27], v72 offset:10240
  s_waitcnt lgkmcnt(6)
  v_mfma_f32_16x16x32_bf16 v[48:51], v[32:35], v[88:91], v[48:51]
  ds_read_b64_tr_b16 v[28:29], v72 offset:12288
  v_mfma_f32_16x16x32_bf16 v[52:55], v[32:35], v[98:101], v[52:55]
  ds_read_b64_tr_b16 v[30:31], v72 offset:14336
  v_mfma_f32_16x16x16_bf16 v[48:51], v[36:37], v[92:93], v[48:51]
  ds_read_b64_tr_b16 v[32:33], v72 offset:16384
  v_mfma_f32_16x16x16_bf16 v[52:55], v[36:37], v[102:103], v[52:55]
  ds_read_b64_tr_b16 v[34:35], v72 offset:18432
  s_waitcnt lgkmcnt(6)
  v_mfma_f32_16x16x32_bf16 v[40:43], v[16:19], v[112:115], 0
  s_add_u32 m0, s88, 16384
  s_add_u32 s45, s39, 7
  s_and_b32 s45, s45, 7
  s_lshl_b32 s45, s45, 7
  s_sub_u32 s96, s45, s95
  s_mov_b32 s95, s45
  v_add_u32 v13, s96, v13
  v_add_u32 v14, s96, v14
  ds_read_b64_tr_b16 v[36:37], v72 offset:20480
  buffer_load_dwordx4 v13, s[16:19], s60 offen offset:0 lds
  v_mfma_f32_16x16x32_bf16 v[44:47], v[16:19], v[116:119], 0
  ds_read_b64_tr_b16 v[38:39], v72 offset:22528
  v_mfma_f32_16x16x32_bf16 v[40:43], v[20:23], v[120:123], v[40:43]
  s_add_u32 m0, s88, 24576
  ds_read_b64_tr_b16 v[16:17], v72 offset:24576
  buffer_load_dwordx4 v13, s[16:19], s61 offen offset:0 lds
  v_mfma_f32_16x16x32_bf16 v[44:47], v[20:23], v[124:127], v[44:47]
  v_cvt_pk_bf16_f32 v80, v48, v49
  v_cvt_pk_bf16_f32 v81, v50, v51
  ds_read_b64_tr_b16 v[18:19], v72 offset:26624
  s_waitcnt vmcnt(6)
  s_barrier
  v_add_u32 v72, 102400, v73
  s_waitcnt lgkmcnt(6)
  v_mfma_f32_16x16x32_bf16 v[40:43], v[24:27], v[128:131], v[40:43]
  s_add_u32 m0, s88, 32768
  v_cvt_pk_bf16_f32 v82, v52, v53
  v_cvt_pk_bf16_f32 v83, v54, v55
  ds_read_b64_tr_b16 v[20:21], v72 offset:0
  buffer_load_dwordx4 v13, s[16:19], s62 offen offset:0 lds
  v_mfma_f32_16x16x32_bf16 v[44:47], v[24:27], v[132:135], v[44:47]
  ds_read_b64_tr_b16 v[22:23], v72 offset:2048
  v_mfma_f32_16x16x32_bf16 v[40:43], v[28:31], v[136:139], v[40:43]
  s_add_u32 m0, s88, 40960
  s_add_u32 s44, s39, 5
  s_and_b32 s44, s44, 7
  s_lshl_b32 s44, s44, 16
  s_add_u32 s44, s44, s84
  buffer_store_dwordx4 v[80:83], v76, s[24:27], s44 offen sc1
  ds_read_b64_tr_b16 v[24:25], v72 offset:4096
  s_cbranch_vccnz L_d49
  buffer_load_dwordx4 v13, s[16:19], s63 offen offset:0 lds
L_d49:
  v_mfma_f32_16x16x32_bf16 v[44:47], v[28:31], v[140:143], v[44:47]
  ds_read_b64_tr_b16 v[26:27], v72 offset:6144
  s_waitcnt lgkmcnt(6)
  v_mfma_f32_16x16x32_bf16 v[40:43], v[32:35], v[144:147], v[40:43]
  ds_read_b64_tr_b16 v[28:29], v72 offset:8192
  v_mfma_f32_16x16x32_bf16 v[44:47], v[32:35], v[148:151], v[44:47]
  ds_read_b64_tr_b16 v[30:31], v72 offset:10240
  v_mfma_f32_16x16x32_bf16 v[40:43], v[36:39], v[152:155], v[40:43]
  ds_read_b64_tr_b16 v[32:33], v72 offset:12288
  v_mfma_f32_16x16x32_bf16 v[44:47], v[36:39], v[156:159], v[44:47]
  ds_read_b64_tr_b16 v[34:35], v72 offset:14336
  s_waitcnt lgkmcnt(6)
  v_mfma_f32_16x16x32_bf16 v[40:43], v[16:19], v[160:163], v[40:43]
  ds_read_b64_tr_b16 v[36:37], v72 offset:16384
  v_mfma_f32_16x16x32_bf16 v[44:47], v[16:19], v[164:167], v[44:47]
  ds_read_b64_tr_b16 v[38:39], v72 offset:18432
  v_mfma_f32_16x16x32_bf16 v[40:43], v[20:23], v[168:171], v[40:43]
  s_add_u32 m0, s88, 45056
  ds_read_b64_tr_b16 v[16:17], v72 offset:20480
  buffer_load_dwordx4 v13, s[16:19], s41 offen offset:0 lds
  v_mfma_f32_16x16x32_bf16 v[44:47], v[20:23], v[172:175], v[44:47]
  ds_read_b64_tr_b16 v[18:19], v72 offset:22528
  s_waitcnt lgkmcnt(6)
  v_mfma_f32_16x16x32_bf16 v[40:43], v[24:27], v[176:179], v[40:43]
  s_add_u32 m0, s88, 53248
  ds_read_b64_tr_b16 v[20:21], v72 offset:24576
  buffer_load_dwordx4 v13, s[16:19], s42 offen offset:0 lds
  v_mfma_f32_16x16x32_bf16 v[44:47], v[24:27], v[180:183], v[44:47]
  ds_read_b64_tr_b16 v[22:23], v72 offset:26624
  s_waitcnt vmcnt(6)
  s_barrier
  v_add_u32 v72, 131072, v73
  v_add_u32 v74, 131072, v75
  v_mfma_f32_16x16x32_bf16 v[40:43], v[28:31], v[184:187], v[40:43]
  s_add_u32 m0, s88, 61440
  ds_read_b64_tr_b16 v[24:25], v72 offset:0
  buffer_load_dwordx4 v13, s[16:19], s43 offen offset:0 lds
  v_mfma_f32_16x16x32_bf16 v[44:47], v[28:31], v[188:191], v[44:47]
  ds_read_b64_tr_b16 v[26:27], v72 offset:2048
  s_waitcnt lgkmcnt(6)
  v_mfma_f32_16x16x32_bf16 v[40:43], v[32:35], v[192:195], v[40:43]
  s_add_u32 m0, s88, 69632
  ds_read_b64_tr_b16 v[28:29], v72 offset:4096
  s_cbranch_vccnz L_d50
  buffer_load_dwordx4 v13, s[16:19], s65 offen offset:0 lds
L_d50:
  v_mfma_f32_16x16x32_bf16 v[44:47], v[32:35], v[196:199], v[44:47]
  ds_read_b64_tr_b16 v[30:31], v72 offset:6144
  v_mfma_f32_16x16x32_bf16 v[40:43], v[36:39], v[200:203], v[40:43]
  ds_read_b64_tr_b16 v[32:33], v72 offset:8192
  v_mfma_f32_16x16x32_bf16 v[44:47], v[36:39], v[204:207], v[44:47]
  ds_read_b64_tr_b16 v[34:35], v72 offset:10240
  s_waitcnt lgkmcnt(6)
  v_mfma_f32_16x16x32_bf16 v[40:43], v[16:19], v[208:211], v[40:43]
  ds_read_b64_tr_b16 v[36:37], v72 offset:12288
  v_mfma_f32_16x16x32_bf16 v[44:47], v[16:19], v[212:215], v[44:47]
  ds_read_b64_tr_b16 v[38:39], v72 offset:14336
  v_mfma_f32_16x16x32_bf16 v[40:43], v[20:23], v[216:219], v[40:43]
  ds_read_b64_tr_b16 v[16:17], v72 offset:16384
  v_mfma_f32_16x16x32_bf16 v[44:47], v[20:23], v[220:223], v[44:47]
  ds_read_b64_tr_b16 v[18:19], v72 offset:18432
  s_waitcnt lgkmcnt(6)
  v_mfma_f32_16x16x32_bf16 v[40:43], v[24:27], v[224:227], v[40:43]
  s_add_u32 m0, s88, 73728
  ds_read_b64_tr_b16 v[20:21], v72 offset:20480
  buffer_load_dwordx4 v13, s[16:19], s85 offen offset:0 lds
  v_mfma_f32_16x16x32_bf16 v[44:47], v[24:27], v[228:231], v[44:47]
  ds_read_b64_tr_b16 v[22:23], v72 offset:22528
  v_mfma_f32_16x16x32_bf16 v[40:43], v[28:31], v[232:235], v[40:43]
  s_add_u32 m0, s88, 81920
  ds_read_b64_tr_b16 v[24:25], v74 offset:24576
  buffer_load_dwordx4 v13, s[16:19], s89 offen offset:0 lds
  v_mfma_f32_16x16x32_bf16 v[44:47], v[28:31], v[236:239], v[44:47]
  s_waitcnt vmcnt(6)
  s_barrier
  v_add_u32 v72, 16384, v73
  s_and_b32 s44, s40, 3
  s_lshl_b32 s44, s44, 3
  s_lshl_b32 s45, 2, s44
  v_and_b32 v104, s45, v104
  v_cmp_eq_u32 vcc, s45, v104
  s_nop 1
  s_cmp_eq_u64 vcc, exec
  s_cbranch_scc1 L_c7_done
  s_mov_b32 s46, 0
  v_and_b32 v3, 7, v0
  v_lshlrev_b32 v3, 5, v3
  s_and_b32 s44, s40, 28
  v_add_u32 v3, s44, v3
L_c7_loop:
  global_load_dword v104, v3, s[28:29] sc0 sc1
  s_waitcnt vmcnt(0)
  v_and_b32 v104, s45, v104
  v_cmp_eq_u32 vcc, s45, v104
  s_nop 1
  s_cmp_eq_u64 vcc, exec
  s_cbranch_scc1 L_c7_done
  s_add_u32 s46, s46, 1
  s_cmp_lt_u32 s46, 0x40000
  s_sleep 4
  s_cbranch_scc1 L_c7_loop
L_c7_done:
  s_waitcnt lgkmcnt(5)
  v_mfma_f32_16x16x32_bf16 v[40:43], v[32:35], v[240:243], v[40:43]
  s_add_u32 m0, s88, 90112
  ds_read_b64_tr_b16 v[28:29], v72 offset:0
  buffer_load_dwordx4 v14, s[20:23], 0 offen offset:0 lds
  v_mfma_f32_16x16x32_bf16 v[44:47], v[32:35], v[244:247], v[44:47]
  ds_read_b64_tr_b16 v[30:31], v72 offset:2048
  v_mfma_f32_16x16x32_bf16 v[40:43], v[36:39], v[248:251], v[40:43]
  s_add_u32 m0, s88, 98304
  ds_read_b64_tr_b16 v[32:33], v72 offset:4096
  s_cmp_ge_u32 s36, 1
  s_cbranch_scc1 L_d51
  buffer_load_dwordx4 v14, s[20:23], s61 offen offset:0 lds
L_d51:
  v_mfma_f32_16x16x32_bf16 v[44:47], v[36:39], v[252:255], v[44:47]
  ds_read_b64_tr_b16 v[34:35], v72 offset:6144
  s_waitcnt lgkmcnt(5)
  v_mfma_f32_16x16x32_bf16 v[40:43], v[16:19], v[84:87], v[40:43]
  ds_read_b64_tr_b16 v[36:37], v72 offset:8192
  v_mfma_f32_16x16x32_bf16 v[44:47], v[16:19], v[94:97], v[44:47]
  ds_read_b64_tr_b16 v[38:39], v72 offset:10240
  v_mfma_f32_16x16x32_bf16 v[40:43], v[20:23], v[88:91], v[40:43]
  ds_read_b64_tr_b16 v[16:17], v72 offset:12288
  v_mfma_f32_16x16x32_bf16 v[44:47], v[20:23], v[98:101], v[44:47]
  ds_read_b64_tr_b16 v[18:19], v72 offset:14336
  s_waitcnt lgkmcnt(6)
  v_mfma_f32_16x16x16_bf16 v[40:43], v[24:25], v[92:93], v[40:43]
  ds_read_b64_tr_b16 v[20:21], v72 offset:16384
  v_mfma_f32_16x16x16_bf16 v[44:47], v[24:25], v[102:103], v[44:47]
  ds_read_b64_tr_b16 v[22:23], v72 offset:18432
  v_mfma_f32_16x16x32_bf16 v[48:51], v[28:31], v[112:115], 0
  s_add_u32 m0, s88, 102400
  s_add_u32 s45, s39, 8
  s_and_b32 s45, s45, 7
  s_lshl_b32 s45, s45, 7
  s_sub_u32 s96, s45, s95
  s_mov_b32 s95, s45
  v_add_u32 v13, s96, v13
  v_add_u32 v14, s96, v14
  ds_read_b64_tr_b16 v[24:25], v72 offset:20480
  buffer_load_dwordx4 v13, s[16:19], s60 offen offset:0 lds
  v_mfma_f32_16x16x32_bf16 v[52:55], v[28:31], v[116:119], 0
  ds_read_b64_tr_b16 v[26:27], v72 offset:22528
  s_waitcnt lgkmcnt(6)
  v_mfma_f32_16x16x32_bf16 v[48:51], v[32:35], v[120:123], v[48:51]
  s_add_u32 m0, s88, 110592
  ds_read_b64_tr_b16 v[28:29], v72 offset:24576
  buffer_load_dwordx4 v13, s[16:19], s61 offen offset:0 lds
  v_mfma_f32_16x16x32_bf16 v[52:55], v[32:35], v[124:127], v[52:55]
  v_cvt_pk_bf16_f32 v80, v40, v41
  v_cvt_pk_bf16_f32 v81, v42, v43
  ds_read_b64_tr_b16 v[30:31], v72 offset:26624
  s_waitcnt vmcnt(5)
  s_barrier
  v_add_u32 v72, 45056, v73
  v_mfma_f32_16x16x32_bf16 v[48:51], v[36:39], v[128:131], v[48:51]
  s_add_u32 m0, s88, 118784
  v_cvt_pk_bf16_f32 v82, v44, v45
  v_cvt_pk_bf16_f32 v83, v46, v47
  ds_read_b64_tr_b16 v[32:33], v72 offset:0
  buffer_load_dwordx4 v13, s[16:19], s62 offen offset:0 lds
  v_mfma_f32_16x16x32_bf16 v[52:55], v[36:39], v[132:135], v[52:55]
  ds_read_b64_tr_b16 v[34:35], v72 offset:2048
  s_waitcnt lgkmcnt(6)
  v_mfma_f32_16x16x32_bf16 v[48:51], v[16:19], v[136:139], v[48:51]
  s_add_u32 m0, s88, 126976
  s_add_u32 s44, s39, 6
  s_and_b32 s44, s44, 7
  s_lshl_b32 s44, s44, 16
  s_add_u32 s44, s44, s84
  buffer_store_dwordx4 v[80:83], v76, s[24:27], s44 offen sc1
  ds_read_b64_tr_b16 v[36:37], v72 offset:4096
  s_cmp_eq_u32 s37, 1
  s_cselect_b64 vcc, -1, 0
  s_cbranch_vccnz L_d52
  buffer_load_dwordx4 v13, s[16:19], s63 offen offset:0 lds
L_d52:
  v_mfma_f32_16x16x32_bf16 v[52:55], v[16:19], v[140:143], v[52:55]
  ds_read_b64_tr_b16 v[38:39], v72 offset:6144
  v_mfma_f32_16x16x32_bf16 v[48:51], v[20:23], v[144:147], v[48:51]
  ds_read_b64_tr_b16 v[16:17], v72 offset:8192
  v_mfma_f32_16x16x32_bf16 v[52:55], v[20:23], v[148:151], v[52:55]
  ds_read_b64_tr_b16 v[18:19], v72 offset:10240
  s_waitcnt lgkmcnt(6)
  v_mfma_f32_16x16x32_bf16 v[48:51], v[24:27], v[152:155], v[48:51]
  ds_read_b64_tr_b16 v[20:21], v72 offset:12288
  v_mfma_f32_16x16x32_bf16 v[52:55], v[24:27], v[156:159], v[52:55]
  ds_read_b64_tr_b16 v[22:23], v72 offset:14336
  v_mfma_f32_16x16x32_bf16 v[48:51], v[28:31], v[160:163], v[48:51]
  ds_read_b64_tr_b16 v[24:25], v72 offset:16384
  v_mfma_f32_16x16x32_bf16 v[52:55], v[28:31], v[164:167], v[52:55]
  ds_read_b64_tr_b16 v[26:27], v72 offset:18432
  s_waitcnt lgkmcnt(6)
  v_mfma_f32_16x16x32_bf16 v[48:51], v[32:35], v[168:171], v[48:51]
  s_add_u32 m0, s88, 131072
  ds_read_b64_tr_b16 v[28:29], v72 offset:20480
  buffer_load_dwordx4 v13, s[16:19], s41 offen offset:0 lds
  v_mfma_f32_16x16x32_bf16 v[52:55], v[32:35], v[172:175], v[52:55]
  ds_read_b64_tr_b16 v[30:31], v72 offset:22528
  v_mfma_f32_16x16x32_bf16 v[48:51], v[36:39], v[176:179], v[48:51]
  s_add_u32 m0, s88, 139264
  ds_read_b64_tr_b16 v[32:33], v72 offset:24576
  buffer_load_dwordx4 v13, s[16:19], s42 offen offset:0 lds
  v_mfma_f32_16x16x32_bf16 v[52:55], v[36:39], v[180:183], v[52:55]
  ds_read_b64_tr_b16 v[34:35], v72 offset:26624
  s_waitcnt vmcnt(6)
  s_barrier
  v_add_u32 v72, 73728, v73
  v_add_u32 v74, 73728, v75
  s_waitcnt lgkmcnt(6)
  v_mfma_f32_16x16x32_bf16 v[48:51], v[16:19], v[184:187], v[48:51]
  s_add_u32 m0, s88, 147456
  ds_read_b64_tr_b16 v[36:37], v72 offset:0
  buffer_load_dwordx4 v13, s[16:19], s43 offen offset:0 lds
  v_mfma_f32_16x16x32_bf16 v[52:55], v[16:19], v[188:191], v[52:55]
  ds_read_b64_tr_b16 v[38:39], v72 offset:2048
  v_mfma_f32_16x16x32_bf16 v[48:51], v[20:23], v[192:195], v[48:51]
  s_add_u32 m0, s88, 155648
  ds_read_b64_tr_b16 v[16:17], v72 offset:4096
  s_cbranch_vccnz L_d53
  buffer_load_dwordx4 v13, s[16:19], s65 offen offset:0 lds
L_d53:
  v_mfma_f32_16x16x32_bf16 v[52:55], v[20:23], v[196:199], v[52:55]
  ds_read_b64_tr_b16 v[18:19], v72 offset:6144
  s_waitcnt lgkmcnt(6)
  v_mfma_f32_16x16x32_bf16 v[48:51], v[24:27], v[200:203], v[48:51]
  ds_read_b64_tr_b16 v[20:21], v72 offset:8192
  v_mfma_f32_16x16x32_bf16 v[52:55], v[24:27], v[204:207], v[52:55]
  ds_read_b64_tr_b16 v[22:23], v72 offset:10240
  v_mfma_f32_16x16x32_bf16 v[48:51], v[28:31], v[208:211], v[48:51]
  ds_read_b64_tr_b16 v[24:25], v72 offset:12288
  v_mfma_f32_16x16x32_bf16 v[52:55], v[28:31], v[212:215], v[52:55]
  ds_read_b64_tr_b16 v[26:27], v72 offset:14336
  s_waitcnt lgkmcnt(6)
  v_mfma_f32_16x16x32_bf16 v[48:51], v[32:35], v[216:219], v[48:51]
  ds_read_b64_tr_b16 v[28:29], v72 offset:16384
  v_mfma_f32_16x16x32_bf16 v[52:55], v[32:35], v[220:223], v[52:55]
  ds_read_b64_tr_b16 v[30:31], v72 offset:18432
  v_mfma_f32_16x16x32_bf16 v[48:51], v[36:39], v[224:227], v[48:51]
  s_add_u32 m0, s88, 16384
  ds_read_b64_tr_b16 v[32:33], v72 offset:20480
  buffer_load_dwordx4 v13, s[16:19], s85 offen offset:0 lds
  v_mfma_f32_16x16x32_bf16 v[52:55], v[36:39], v[228:231], v[52:55]
  ds_read_b64_tr_b16 v[34:35], v72 offset:22528
  s_waitcnt lgkmcnt(6)
  v_mfma_f32_16x16x32_bf16 v[48:51], v[16:19], v[232:235], v[48:51]
  s_add_u32 m0, s88, 24576
  ds_read_b64_tr_b16 v[36:37], v74 offset:24576
  buffer_load_dwordx4 v13, s[16:19], s89 offen offset:0 lds
  v_mfma_f32_16x16x32_bf16 v[52:55], v[16:19], v[236:239], v[52:55]
  s_waitcnt vmcnt(6)
  s_barrier
  v_add_u32 v72, 102400, v73
  v_mfma_f32_16x16x32_bf16 v[48:51], v[20:23], v[240:243], v[48:51]
  s_add_u32 m0, s88, 32768
  ds_read_b64_tr_b16 v[16:17], v72 offset:0
  buffer_load_dwordx4 v14, s[20:23], 0 offen offset:0 lds
  v_mfma_f32_16x16x32_bf16 v[52:55], v[20:23], v[244:247], v[52:55]
  ds_read_b64_tr_b16 v[18:19], v72 offset:2048
  s_waitcnt lgkmcnt(5)
  v_mfma_f32_16x16x32_bf16 v[48:51], v[24:27], v[248:251], v[48:51]
  s_add_u32 m0, s88, 40960
  ds_read_b64_tr_b16 v[20:21], v72 offset:4096
  s_cmp_ge_u32 s36, 1
  s_cbranch_scc1 L_d54
  buffer_load_dwordx4 v14, s[20:23], s61 offen offset:0 lds
L_d54:
  v_mfma_f32_16x16x32_bf16 v[52:55], v[24:27], v[252:255], v[52:55]
  ds_read_b64_tr_b16 v[22:23], v72 offset:6144
  v_mfma_f32_16x16x32_bf16 v[48:51], v[28:31], v[84:87], v[48:51]
  ds_read_b64_tr_b16 v[24:25], v72 offset:8192
  v_mfma_f32_16x16x32_bf16 v[52:55], v[28:31], v[94:97], v[52:55]
  ds_read_b64_tr_b16 v[26:27], v72 offset:10240
  s_waitcnt lgkmcnt(6)
  v_mfma_f32_16x16x32_bf16 v[48:51], v[32:35], v[88:91], v[48:51]
  ds_read_b64_tr_b16 v[28:29], v72 offset:12288
  v_mfma_f32_16x16x32_bf16 v[52:55], v[32:35], v[98:101], v[52:55]
  ds_read_b64_tr_b16 v[30:31], v72 offset:14336
  v_mfma_f32_16x16x16_bf16 v[48:51], v[36:37], v[92:93], v[48:51]
  ds_read_b64_tr_b16 v[32:33], v72 offset:16384
  v_mfma_f32_16x16x16_bf16 v[52:55], v[36:37], v[102:103], v[52:55]
  ds_read_b64_tr_b16 v[34:35], v72 offset:18432
  s_waitcnt lgkmcnt(6)
  v_mfma_f32_16x16x32_bf16 v[40:43], v[16:19], v[112:115], 0
  ds_read_b64_tr_b16 v[36:37], v72 offset:20480
  v_mfma_f32_16x16x32_bf16 v[44:47], v[16:19], v[116:119], 0
  ds_read_b64_tr_b16 v[38:39], v72 offset:22528
  v_mfma_f32_16x16x32_bf16 v[40:43], v[20:23], v[120:123], v[40:43]
  ds_read_b64_tr_b16 v[16:17], v72 offset:24576
  v_mfma_f32_16x16x32_bf16 v[44:47], v[20:23], v[124:127], v[44:47]
  v_cvt_pk_bf16_f32 v80, v48, v49
  v_cvt_pk_bf16_f32 v81, v50, v51
  ds_read_b64_tr_b16 v[18:19], v72 offset:26624
  s_waitcnt vmcnt(3)
  s_barrier
  v_add_u32 v72, 131072, v73
  s_cmp_lg_u32 s36, 0
  s_cbranch_scc1 L_nopub6
  s_lshl_b32 s44, s40, 7
  s_add_u32 s44, s44, 44040192
  s_lshl_b32 s45, s39, 2
  v_cmp_eq_u32 s[66:67], 0, v0
  v_mov_b32 v3, 0x7f000000
  v_mov_b32 v4, s45
  v_cndmask_b32 v3, v3, v4, s[66:67]
  v_mov_b32 v4, 7
  buffer_store_dword v4, v3, s[24:27], s44 offen sc0 sc1
L_nopub6:
  s_waitcnt lgkmcnt(6)
  v_mfma_f32_16x16x32_bf16 v[40:43], v[24:27], v[128:131], v[40:43]
  v_cvt_pk_bf16_f32 v82, v52, v53
  v_cvt_pk_bf16_f32 v83, v54, v55
  ds_read_b64_tr_b16 v[20:21], v72 offset:0
  v_mfma_f32_16x16x32_bf16 v[44:47], v[24:27], v[132:135], v[44:47]
  ds_read_b64_tr_b16 v[22:23], v72 offset:2048
  v_mfma_f32_16x16x32_bf16 v[40:43], v[28:31], v[136:139], v[40:43]
  s_add_u32 s44, s39, 7
  s_and_b32 s44, s44, 7
  s_lshl_b32 s44, s44, 16
  s_add_u32 s44, s44, s84
  buffer_store_dwordx4 v[80:83], v76, s[24:27], s44 offen sc1
  ds_read_b64_tr_b16 v[24:25], v72 offset:4096
  v_mfma_f32_16x16x32_bf16 v[44:47], v[28:31], v[140:143], v[44:47]
  ds_read_b64_tr_b16 v[26:27], v72 offset:6144
  s_waitcnt lgkmcnt(6)
  v_mfma_f32_16x16x32_bf16 v[40:43], v[32:35], v[144:147], v[40:43]
  ds_read_b64_tr_b16 v[28:29], v72 offset:8192
  v_mfma_f32_16x16x32_bf16 v[44:47], v[32:35], v[148:151], v[44:47]
  ds_read_b64_tr_b16 v[30:31], v72 offset:10240
  v_mfma_f32_16x16x32_bf16 v[40:43], v[36:39], v[152:155], v[40:43]
  ds_read_b64_tr_b16 v[32:33], v72 offset:12288
  v_mfma_f32_16x16x32_bf16 v[44:47], v[36:39], v[156:159], v[44:47]
  ds_read_b64_tr_b16 v[34:35], v72 offset:14336
  s_waitcnt lgkmcnt(6)
  v_mfma_f32_16x16x32_bf16 v[40:43], v[16:19], v[160:163], v[40:43]
  ds_read_b64_tr_b16 v[36:37], v72 offset:16384
  v_mfma_f32_16x16x32_bf16 v[44:47], v[16:19], v[164:167], v[44:47]
  ds_read_b64_tr_b16 v[38:39], v72 offset:18432
  v_mfma_f32_16x16x32_bf16 v[40:43], v[20:23], v[168:171], v[40:43]
  ds_read_b64_tr_b16 v[16:17], v72 offset:20480
  v_mfma_f32_16x16x32_bf16 v[44:47], v[20:23], v[172:175], v[44:47]
  ds_read_b64_tr_b16 v[18:19], v72 offset:22528
  s_waitcnt lgkmcnt(6)
  v_mfma_f32_16x16x32_bf16 v[40:43], v[24:27], v[176:179], v[40:43]
  ds_read_b64_tr_b16 v[20:21], v72 offset:24576
  v_mfma_f32_16x16x32_bf16 v[44:47], v[24:27], v[180:183], v[44:47]
  ds_read_b64_tr_b16 v[22:23], v72 offset:26624
  s_waitcnt vmcnt(1)
  s_barrier
  v_add_u32 v72, 16384, v73
  v_add_u32 v74, 16384, v75
  v_and_b32 v105, 7, v0
  v_lshlrev_b32 v105, 2, v105
  s_lshl_b32 s44, s40, 7
  s_add_u32 s44, s44, 44040192
  buffer_load_dword v105, v105, s[24:27], s44 offen sc0 sc1
  v_and_b32 v3, 1, v2
  v_lshl_add_u32 v3, v3, 4, v1
  v_lshrrev_b32 v4, 1, v2
  v_lshlrev_b32 v4, 4, v4
  s_lshl_b32 s44, s40, 6
  s_lshl_b32 s45, s37, 5
  s_add_u32 s45, s45, s44
  v_add_u32 v106, s45, v3
  v_mul_u32_u24 v106, 1152, v106
  s_lshl_b32 s46, s39, 7
  s_lshl_b32 s47, s38, 5
  s_add_u32 s46, s46, s47
  v_add_u32 v107, s46, v4
  v_add_u32 v106, v106, v107
  s_lshr_b32 s45, s39, 2
  s_lshl_b32 s45, s45, 5
  s_add_u32 s45, s45, s44
  v_add_u32 v108, s45, v3
  v_mul_u32_u24 v108, 1152, v108
  s_and_b32 s46, s39, 3
  s_lshl_b32 s46, s46, 5
  s_add_u32 s46, s46, 1024
  v_add_u32 v109, s46, v4
  v_add_u32 v108, v108, v109
  buffer_load_dwordx4 v[56:59], v106, s[4:7], 0 offen
  buffer_load_dwordx4 v[60:63], v107, s[12:15], 0 offen
  buffer_load_dwordx4 v[64:67], v108, s[4:7], 0 offen
  buffer_load_dwordx4 v[68:71], v109, s[12:15], 0 offen
  v_mfma_f32_16x16x32_bf16 v[40:43], v[28:31], v[184:187], v[40:43]
  ds_read_b64_tr_b16 v[24:25], v72 offset:0
  v_mfma_f32_16x16x32_bf16 v[44:47], v[28:31], v[188:191], v[44:47]
  ds_read_b64_tr_b16 v[26:27], v72 offset:2048
  s_waitcnt lgkmcnt(6)
  v_mfma_f32_16x16x32_bf16 v[40:43], v[32:35], v[192:195], v[40:43]
  ds_read_b64_tr_b16 v[28:29], v72 offset:4096
  v_mfma_f32_16x16x32_bf16 v[44:47], v[32:35], v[196:199], v[44:47]
  ds_read_b64_tr_b16 v[30:31], v72 offset:6144
  v_mfma_f32_16x16x32_bf16 v[40:43], v[36:39], v[200:203], v[40:43]
  ds_read_b64_tr_b16 v[32:33], v72 offset:8192
  v_mfma_f32_16x16x32_bf16 v[44:47], v[36:39], v[204:207], v[44:47]
  ds_read_b64_tr_b16 v[34:35], v72 offset:10240
  s_waitcnt lgkmcnt(6)
  v_mfma_f32_16x16x32_bf16 v[40:43], v[16:19], v[208:211], v[40:43]
  ds_read_b64_tr_b16 v[36:37], v72 offset:12288
  v_mfma_f32_16x16x32_bf16 v[44:47], v[16:19], v[212:215], v[44:47]
  ds_read_b64_tr_b16 v[38:39], v72 offset:14336
  v_mfma_f32_16x16x32_bf16 v[40:43], v[20:23], v[216:219], v[40:43]
  ds_read_b64_tr_b16 v[16:17], v72 offset:16384
  v_mfma_f32_16x16x32_bf16 v[44:47], v[20:23], v[220:223], v[44:47]
  ds_read_b64_tr_b16 v[18:19], v72 offset:18432
  s_waitcnt lgkmcnt(6)
  v_mfma_f32_16x16x32_bf16 v[40:43], v[24:27], v[224:227], v[40:43]
  ds_read_b64_tr_b16 v[20:21], v72 offset:20480
  v_mfma_f32_16x16x32_bf16 v[44:47], v[24:27], v[228:231], v[44:47]
  ds_read_b64_tr_b16 v[22:23], v72 offset:22528
  v_mfma_f32_16x16x32_bf16 v[40:43], v[28:31], v[232:235], v[40:43]
  ds_read_b64_tr_b16 v[24:25], v74 offset:24576
  v_mfma_f32_16x16x32_bf16 v[44:47], v[28:31], v[236:239], v[44:47]
  s_waitcnt lgkmcnt(5)
  v_mfma_f32_16x16x32_bf16 v[40:43], v[32:35], v[240:243], v[40:43]
  v_mfma_f32_16x16x32_bf16 v[44:47], v[32:35], v[244:247], v[44:47]
  v_mfma_f32_16x16x32_bf16 v[40:43], v[36:39], v[248:251], v[40:43]
  v_mfma_f32_16x16x32_bf16 v[44:47], v[36:39], v[252:255], v[44:47]
  s_waitcnt lgkmcnt(3)
  v_mfma_f32_16x16x32_bf16 v[40:43], v[16:19], v[84:87], v[40:43]
  v_mfma_f32_16x16x32_bf16 v[44:47], v[16:19], v[94:97], v[44:47]
  s_waitcnt lgkmcnt(1)
  v_mfma_f32_16x16x32_bf16 v[40:43], v[20:23], v[88:91], v[40:43]
  v_mfma_f32_16x16x32_bf16 v[44:47], v[20:23], v[98:101], v[44:47]
  s_waitcnt lgkmcnt(0)
  v_mfma_f32_16x16x16_bf16 v[40:43], v[24:25], v[92:93], v[40:43]
  v_mfma_f32_16x16x16_bf16 v[44:47], v[24:25], v[102:103], v[44:47]
  v_lshlrev_b32 v38, 4, v0
  v_and_b32 v5, 7, v0
  v_sub_u32 v39, s39, v5
  v_and_b32 v39, 7, v39
  v_add_u32 v39, 1, v39
  v_cmp_eq_u32 vcc, 8, v39
  v_and_b32 v37, 7, v39
  s_mov_b32 s87, 0x40088e99
  s_mul_i32 s47, s40, 589824
  s_add_u32 s47, s47, 0
  s_lshl_b32 s48, s39, 16
  s_add_u32 s48, s48, s47
  s_lshl_b32 s49, s36, 13
  s_add_u32 s48, s48, s49
  s_lshl_b32 s49, s39, 13
  s_add_u32 s49, s49, s47
  s_add_u32 s49, s49, 524288
  s_waitcnt vmcnt(5)
  s_barrier
  s_cmp_lg_u32 s36, 0
  s_cbranch_scc1 L_nopub7
  s_lshl_b32 s44, s40, 7
  s_add_u32 s44, s44, 44040192
  s_lshl_b32 s45, s39, 2
  v_cmp_eq_u32 s[66:67], 0, v0
  v_mov_b32 v3, 0x7f000000
  v_mov_b32 v4, s45
  v_cndmask_b32 v3, v3, v4, s[66:67]
  v_mov_b32 v4, 8
  buffer_store_dword v4, v3, s[24:27], s44 offen sc0 sc1
L_nopub7:
  s_waitcnt vmcnt(4)
  v_and_b32 v5, 7, v0
  v_lshlrev_b32 v3, 2, v5
  s_lshl_b32 s44, s40, 7
  s_add_u32 s44, s44, 44040192
  s_mov_b32 s46, 0
  v_cmp_ge_u32 vcc, v105, v37
  s_nop 1
  s_cmp_eq_u64 vcc, exec
  s_cbranch_scc1 L_r6_done
L_r6_loop:
  buffer_load_dword v105, v3, s[24:27], s44 offen sc0 sc1
  s_waitcnt vmcnt(0)
  v_cmp_ge_u32 vcc, v105, v37
  s_nop 1
  s_cmp_eq_u64 vcc, exec
  s_cbranch_scc1 L_r6_done
  s_add_u32 s46, s46, 1
  s_cmp_lt_u32 s46, 0x40000
  s_sleep 2
  s_cbranch_scc1 L_r6_loop
L_r6_done:
  s_cmp_lg_u32 s36, 7
  s_cbranch_scc1 L_r8_skip
  s_add_u32 s44, s49, 0
  buffer_load_dwordx4 v[144:147], v38, s[24:27], s44 offen sc1
  s_add_u32 s44, s49, 1024
  buffer_load_dwordx4 v[148:151], v38, s[24:27], s44 offen sc1
  s_add_u32 s44, s49, 2048
  buffer_load_dwordx4 v[152:155], v38, s[24:27], s44 offen sc1
  s_add_u32 s44, s49, 3072
  buffer_load_dwordx4 v[156:159], v38, s[24:27], s44 offen sc1
  s_add_u32 s44, s49, 4096
  buffer_load_dwordx4 v[160:163], v38, s[24:27], s44 offen sc1
  s_add_u32 s44, s49, 5120
  buffer_load_dwordx4 v[164:167], v38, s[24:27], s44 offen sc1
  s_add_u32 s44, s49, 6144
  buffer_load_dwordx4 v[168:171], v38, s[24:27], s44 offen sc1
  s_add_u32 s44, s49, 7168
  buffer_load_dwordx4 v[172:175], v38, s[24:27], s44 offen sc1
L_r8_skip:
  s_add_u32 s44, s39, 2
  s_and_b32 s44, s44, 7
  s_lshl_b32 s44, s44, 10
  s_add_u32 s44, s44, s48
  buffer_load_dwordx4 v[112:115], v38, s[24:27], s44 offen sc1
  s_add_u32 s44, s39, 3
  s_and_b32 s44, s44, 7
  s_lshl_b32 s44, s44, 10
  s_add_u32 s44, s44, s48
  buffer_load_dwordx4 v[116:119], v38, s[24:27], s44 offen sc1
  s_add_u32 s44, s39, 4
  s_and_b32 s44, s44, 7
  s_lshl_b32 s44, s44, 10
  s_add_u32 s44, s44, s48
  buffer_load_dwordx4 v[120:123], v38, s[24:27], s44 offen sc1
  s_add_u32 s44, s39, 5
  s_and_b32 s44, s44, 7
  s_lshl_b32 s44, s44, 10
  s_add_u32 s44, s44, s48
  buffer_load_dwordx4 v[124:127], v38, s[24:27], s44 offen sc1
  s_add_u32 s44, s39, 6
  s_and_b32 s44, s44, 7
  s_lshl_b32 s44, s44, 10
  s_add_u32 s44, s44, s48
  buffer_load_dwordx4 v[128:131], v38, s[24:27], s44 offen sc1
  s_add_u32 s44, s39, 7
  s_and_b32 s44, s44, 7
  s_lshl_b32 s44, s44, 10
  s_add_u32 s44, s44, s48
  buffer_load_dwordx4 v[132:135], v38, s[24:27], s44 offen sc1
  v_and_b32 v5, 7, v0
  v_lshlrev_b32 v3, 2, v5
  s_lshl_b32 s44, s40, 7
  s_add_u32 s44, s44, 44040192
  s_mov_b32 s46, 0
L_r7_loop:
  buffer_load_dword v105, v3, s[24:27], s44 offen sc0 sc1
  s_waitcnt vmcnt(0)
  v_cmp_ge_u32 vcc, v105, v39
  s_nop 1
  s_cmp_eq_u64 vcc, exec
  s_cbranch_scc1 L_r7_done
  s_add_u32 s46, s46, 1
  s_cmp_lt_u32 s46, 0x40000
  s_sleep 2
  s_cbranch_scc1 L_r7_loop
L_r7_done:
  s_add_u32 s44, s39, 1
  s_and_b32 s44, s44, 7
  s_lshl_b32 s44, s44, 10
  s_add_u32 s44, s44, s48
  buffer_load_dwordx4 v[136:139], v38, s[24:27], s44 offen sc1
  v_lshlrev_b32 v3, 16, v112
  v_and_b32 v4, 0xffff0000, v112
  v_add_f32 v40, v40, v3
  v_add_f32 v41, v41, v4
  v_lshlrev_b32 v3, 16, v113
  v_and_b32 v4, 0xffff0000, v113
  v_add_f32 v42, v42, v3
  v_add_f32 v43, v43, v4
  v_lshlrev_b32 v3, 16, v114
  v_and_b32 v4, 0xffff0000, v114
  v_add_f32 v44, v44, v3
  v_add_f32 v45, v45, v4
  v_lshlrev_b32 v3, 16, v115
  v_and_b32 v4, 0xffff0000, v115
  v_add_f32 v46, v46, v3
  v_add_f32 v47, v47, v4
  v_lshlrev_b32 v3, 16, v116
  v_and_b32 v4, 0xffff0000, v116
  v_add_f32 v40, v40, v3
  v_add_f32 v41, v41, v4
  v_lshlrev_b32 v3, 16, v117
  v_and_b32 v4, 0xffff0000, v117
  v_add_f32 v42, v42, v3
  v_add_f32 v43, v43, v4
  v_lshlrev_b32 v3, 16, v118
  v_and_b32 v4, 0xffff0000, v118
  v_add_f32 v44, v44, v3
  v_add_f32 v45, v45, v4
  v_lshlrev_b32 v3, 16, v119
  v_and_b32 v4, 0xffff0000, v119
  v_add_f32 v46, v46, v3
  v_add_f32 v47, v47, v4
  v_lshlrev_b32 v3, 16, v120
  v_and_b32 v4, 0xffff0000, v120
  v_add_f32 v40, v40, v3
  v_add_f32 v41, v41, v4
  v_lshlrev_b32 v3, 16, v121
  v_and_b32 v4, 0xffff0000, v121
  v_add_f32 v42, v42, v3
  v_add_f32 v43, v43, v4
  v_lshlrev_b32 v3, 16, v122
  v_and_b32 v4, 0xffff0000, v122
  v_add_f32 v44, v44, v3
  v_add_f32 v45, v45, v4
  v_lshlrev_b32 v3, 16, v123
  v_and_b32 v4, 0xffff0000, v123
  v_add_f32 v46, v46, v3
  v_add_f32 v47, v47, v4
  v_lshlrev_b32 v3, 16, v124
  v_and_b32 v4, 0xffff0000, v124
  v_add_f32 v40, v40, v3
  v_add_f32 v41, v41, v4
  v_lshlrev_b32 v3, 16, v125
  v_and_b32 v4, 0xffff0000, v125
  v_add_f32 v42, v42, v3
  v_add_f32 v43, v43, v4
  v_lshlrev_b32 v3, 16, v126
  v_and_b32 v4, 0xffff0000, v126
  v_add_f32 v44, v44, v3
  v_add_f32 v45, v45, v4
  v_lshlrev_b32 v3, 16, v127
  v_and_b32 v4, 0xffff0000, v127
  v_add_f32 v46, v46, v3
  v_add_f32 v47, v47, v4
  v_lshlrev_b32 v3, 16, v128
  v_and_b32 v4, 0xffff0000, v128
  v_add_f32 v40, v40, v3
  v_add_f32 v41, v41, v4
  v_lshlrev_b32 v3, 16, v129
  v_and_b32 v4, 0xffff0000, v129
  v_add_f32 v42, v42, v3
  v_add_f32 v43, v43, v4
  v_lshlrev_b32 v3, 16, v130
  v_and_b32 v4, 0xffff0000, v130
  v_add_f32 v44, v44, v3
  v_add_f32 v45, v45, v4
  v_lshlrev_b32 v3, 16, v131
  v_and_b32 v4, 0xffff0000, v131
  v_add_f32 v46, v46, v3
  v_add_f32 v47, v47, v4
  v_lshlrev_b32 v3, 16, v132
  v_and_b32 v4, 0xffff0000, v132
  v_add_f32 v40, v40, v3
  v_add_f32 v41, v41, v4
  v_lshlrev_b32 v3, 16, v133
  v_and_b32 v4, 0xffff0000, v133
  v_add_f32 v42, v42, v3
  v_add_f32 v43, v43, v4
  v_lshlrev_b32 v3, 16, v134
  v_and_b32 v4, 0xffff0000, v134
  v_add_f32 v44, v44, v3
  v_add_f32 v45, v45, v4
  v_lshlrev_b32 v3, 16, v135
  v_and_b32 v4, 0xffff0000, v135
  v_add_f32 v46, v46, v3
  v_add_f32 v47, v47, v4
  s_cmp_lg_u32 s36, 7
  s_cbranch_scc1 L_red_8
  v_lshlrev_b32 v176, 16, v144
  v_and_b32 v177, 0xffff0000, v144
  v_lshlrev_b32 v178, 16, v145
  v_and_b32 v179, 0xffff0000, v145
  v_lshlrev_b32 v180, 16, v146
  v_and_b32 v181, 0xffff0000, v146
  v_lshlrev_b32 v182, 16, v147
  v_and_b32 v183, 0xffff0000, v147
  v_lshlrev_b32 v3, 16, v148
  v_and_b32 v4, 0xffff0000, v148
  v_add_f32 v176, v176, v3
  v_add_f32 v177, v177, v4
  v_lshlrev_b32 v3, 16, v149
  v_and_b32 v4, 0xffff0000, v149
  v_add_f32 v178, v178, v3
  v_add_f32 v179, v179, v4
  v_lshlrev_b32 v3, 16, v150
  v_and_b32 v4, 0xffff0000, v150
  v_add_f32 v180, v180, v3
  v_add_f32 v181, v181, v4
  v_lshlrev_b32 v3, 16, v151
  v_and_b32 v4, 0xffff0000, v151
  v_add_f32 v182, v182, v3
  v_add_f32 v183, v183, v4
  v_lshlrev_b32 v3, 16, v152
  v_and_b32 v4, 0xffff0000, v152
  v_add_f32 v176, v176, v3
  v_add_f32 v177, v177, v4
  v_lshlrev_b32 v3, 16, v153
  v_and_b32 v4, 0xffff0000, v153
  v_add_f32 v178, v178, v3
  v_add_f32 v179, v179, v4
  v_lshlrev_b32 v3, 16, v154
  v_and_b32 v4, 0xffff0000, v154
  v_add_f32 v180, v180, v3
  v_add_f32 v181, v181, v4
  v_lshlrev_b32 v3, 16, v155
  v_and_b32 v4, 0xffff0000, v155
  v_add_f32 v182, v182, v3
  v_add_f32 v183, v183, v4
  v_lshlrev_b32 v3, 16, v156
  v_and_b32 v4, 0xffff0000, v156
  v_add_f32 v176, v176, v3
  v_add_f32 v177, v177, v4
  v_lshlrev_b32 v3, 16, v157
  v_and_b32 v4, 0xffff0000, v157
  v_add_f32 v178, v178, v3
  v_add_f32 v179, v179, v4
  v_lshlrev_b32 v3, 16, v158
  v_and_b32 v4, 0xffff0000, v158
  v_add_f32 v180, v180, v3
  v_add_f32 v181, v181, v4
  v_lshlrev_b32 v3, 16, v159
  v_and_b32 v4, 0xffff0000, v159
  v_add_f32 v182, v182, v3
  v_add_f32 v183, v183, v4
  v_lshlrev_b32 v3, 16, v160
  v_and_b32 v4, 0xffff0000, v160
  v_add_f32 v176, v176, v3
  v_add_f32 v177, v177, v4
  v_lshlrev_b32 v3, 16, v161
  v_and_b32 v4, 0xffff0000, v161
  v_add_f32 v178, v178, v3
  v_add_f32 v179, v179, v4
  v_lshlrev_b32 v3, 16, v162
  v_and_b32 v4, 0xffff0000, v162
  v_add_f32 v180, v180, v3
  v_add_f32 v181, v181, v4
  v_lshlrev_b32 v3, 16, v163
  v_and_b32 v4, 0xffff0000, v163
  v_add_f32 v182, v182, v3
  v_add_f32 v183, v183, v4
  v_lshlrev_b32 v3, 16, v164
  v_and_b32 v4, 0xffff0000, v164
  v_add_f32 v176, v176, v3
  v_add_f32 v177, v177, v4
  v_lshlrev_b32 v3, 16, v165
  v_and_b32 v4, 0xffff0000, v165
  v_add_f32 v178, v178, v3
  v_add_f32 v179, v179, v4
  v_lshlrev_b32 v3, 16, v166
  v_and_b32 v4, 0xffff0000, v166
  v_add_f32 v180, v180, v3
  v_add_f32 v181, v181, v4
  v_lshlrev_b32 v3, 16, v167
  v_and_b32 v4, 0xffff0000, v167
  v_add_f32 v182, v182, v3
  v_add_f32 v183, v183, v4
  v_lshlrev_b32 v3, 16, v168
  v_and_b32 v4, 0xffff0000, v168
  v_add_f32 v176, v176, v3
  v_add_f32 v177, v177, v4
  v_lshlrev_b32 v3, 16, v169
  v_and_b32 v4, 0xffff0000, v169
  v_add_f32 v178, v178, v3
  v_add_f32 v179, v179, v4
  v_lshlrev_b32 v3, 16, v170
  v_and_b32 v4, 0xffff0000, v170
  v_add_f32 v180, v180, v3
  v_add_f32 v181, v181, v4
  v_lshlrev_b32 v3, 16, v171
  v_and_b32 v4, 0xffff0000, v171
  v_add_f32 v182, v182, v3
  v_add_f32 v183, v183, v4
  v_lshlrev_b32 v3, 16, v172
  v_and_b32 v4, 0xffff0000, v172
  v_add_f32 v176, v176, v3
  v_add_f32 v177, v177, v4
  v_lshlrev_b32 v3, 16, v173
  v_and_b32 v4, 0xffff0000, v173
  v_add_f32 v178, v178, v3
  v_add_f32 v179, v179, v4
  v_lshlrev_b32 v3, 16, v174
  v_and_b32 v4, 0xffff0000, v174
  v_add_f32 v180, v180, v3
  v_add_f32 v181, v181, v4
  v_lshlrev_b32 v3, 16, v175
  v_and_b32 v4, 0xffff0000, v175
  v_add_f32 v182, v182, v3
  v_add_f32 v183, v183, v4
  v_permlane16_swap_b32 v176, v180
  v_permlane16_swap_b32 v177, v181
  v_permlane16_swap_b32 v178, v182
  v_permlane16_swap_b32 v179, v183
  v_lshlrev_b32 v3, 16, v64
  v_lshlrev_b32 v4, 16, v68
  v_add_f32 v5, v3, v4
  v_and_b32 v3, 0xffff0000, v64
  v_and_b32 v4, 0xffff0000, v68
  v_add_f32 v6, v3, v4
  v_fma_f32 v176, v176, s87, v5
  v_fma_f32 v177, v177, s87, v6
  v_lshlrev_b32 v3, 16, v65
  v_lshlrev_b32 v4, 16, v69
  v_add_f32 v5, v3, v4
  v_and_b32 v3, 0xffff0000, v65
  v_and_b32 v4, 0xffff0000, v69
  v_add_f32 v6, v3, v4
  v_fma_f32 v178, v178, s87, v5
  v_fma_f32 v179, v179, s87, v6
  v_lshlrev_b32 v3, 16, v66
  v_lshlrev_b32 v4, 16, v70
  v_add_f32 v5, v3, v4
  v_and_b32 v3, 0xffff0000, v66
  v_and_b32 v4, 0xffff0000, v70
  v_add_f32 v6, v3, v4
  v_fma_f32 v180, v180, s87, v5
  v_fma_f32 v181, v181, s87, v6
  v_lshlrev_b32 v3, 16, v67
  v_lshlrev_b32 v4, 16, v71
  v_add_f32 v5, v3, v4
  v_and_b32 v3, 0xffff0000, v67
  v_and_b32 v4, 0xffff0000, v71
  v_add_f32 v6, v3, v4
  v_fma_f32 v182, v182, s87, v5
  v_fma_f32 v183, v183, s87, v6
  v_cvt_pk_bf16_f32 v176, v176, v177
  v_cvt_pk_bf16_f32 v177, v178, v179
  v_cvt_pk_bf16_f32 v178, v180, v181
  v_cvt_pk_bf16_f32 v179, v182, v183
  buffer_store_dwordx4 v[176:179], v108, s[8:11], 0 offen
  s_waitcnt vmcnt(1)
  s_branch L_red_go
L_red_8:
  s_waitcnt vmcnt(0)
L_red_go:
  v_lshlrev_b32 v3, 16, v136
  v_and_b32 v4, 0xffff0000, v136
  v_add_f32 v40, v40, v3
  v_add_f32 v41, v41, v4
  v_lshlrev_b32 v3, 16, v137
  v_and_b32 v4, 0xffff0000, v137
  v_add_f32 v42, v42, v3
  v_add_f32 v43, v43, v4
  v_lshlrev_b32 v3, 16, v138
  v_and_b32 v4, 0xffff0000, v138
  v_add_f32 v44, v44, v3
  v_add_f32 v45, v45, v4
  v_lshlrev_b32 v3, 16, v139
  v_and_b32 v4, 0xffff0000, v139
  v_add_f32 v46, v46, v3
  v_add_f32 v47, v47, v4
  v_permlane16_swap_b32 v40, v44
  v_permlane16_swap_b32 v41, v45
  v_permlane16_swap_b32 v42, v46
  v_permlane16_swap_b32 v43, v47
  v_lshlrev_b32 v3, 16, v56
  v_lshlrev_b32 v4, 16, v60
  v_add_f32 v5, v3, v4
  v_and_b32 v3, 0xffff0000, v56
  v_and_b32 v4, 0xffff0000, v60
  v_add_f32 v6, v3, v4
  v_fma_f32 v40, v40, s87, v5
  v_fma_f32 v41, v41, s87, v6
  v_lshlrev_b32 v3, 16, v57
  v_lshlrev_b32 v4, 16, v61
  v_add_f32 v5, v3, v4
  v_and_b32 v3, 0xffff0000, v57
  v_and_b32 v4, 0xffff0000, v61
  v_add_f32 v6, v3, v4
  v_fma_f32 v42, v42, s87, v5
  v_fma_f32 v43, v43, s87, v6
  v_lshlrev_b32 v3, 16, v58
  v_lshlrev_b32 v4, 16, v62
  v_add_f32 v5, v3, v4
  v_and_b32 v3, 0xffff0000, v58
  v_and_b32 v4, 0xffff0000, v62
  v_add_f32 v6, v3, v4
  v_fma_f32 v44, v44, s87, v5
  v_fma_f32 v45, v45, s87, v6
  v_lshlrev_b32 v3, 16, v59
  v_lshlrev_b32 v4, 16, v63
  v_add_f32 v5, v3, v4
  v_and_b32 v3, 0xffff0000, v59
  v_and_b32 v4, 0xffff0000, v63
  v_add_f32 v6, v3, v4
  v_fma_f32 v46, v46, s87, v5
  v_fma_f32 v47, v47, s87, v6
  v_cvt_pk_bf16_f32 v40, v40, v41
  v_cvt_pk_bf16_f32 v41, v42, v43
  v_cvt_pk_bf16_f32 v42, v44, v45
  v_cvt_pk_bf16_f32 v43, v46, v47
  buffer_store_dwordx4 v[40:43], v106, s[8:11], 0 offen
L_end:
  s_endpgm
.section .rodata,"a"
.p2align 6
.amdhsa_kernel parallel_sum__linear_attn_block__mixer_channel_mlp__prompt_kernel
  .amdhsa_next_free_vgpr 256
  .amdhsa_next_free_sgpr 100
  .amdhsa_accum_offset 256
  .amdhsa_group_segment_fixed_size 0
  .amdhsa_kernarg_size 88
  .amdhsa_user_sgpr_count 2
  .amdhsa_user_sgpr_kernarg_segment_ptr 1
  .amdhsa_system_sgpr_workgroup_id_x 1
.end_amdhsa_kernel
.text
```
